```python
import torch

def _softmax(x, axis=-1):
    return torch.softmax(x, dim=axis)
def _gelu(x):
    return torch.nn.functional.gelu(x, approximate="tanh")
def _silu(x):
    return torch.nn.functional.silu(x)
def _sigmoid(x):
    return torch.sigmoid(x)
def _layernorm(x, axis=-1, eps=1e-5):
    m = x.mean(dim=axis, keepdim=True)
    v = x.var(dim=axis, keepdim=True, unbiased=False)
    return (x - m) / torch.sqrt(v + eps)
def _scatter_add(tgt, idx, src, axis=0):
    return tgt.clone().index_add_(axis, idx, src)
def _segment_sum(src, seg, n):
    out = torch.zeros((n,) + src.shape[1:], dtype=src.dtype)
    return out.index_add_(0, seg, src)
def _pad(x, pw):
    flat = tuple(v for pair in reversed(pw) for v in pair)
    return torch.nn.functional.pad(x, flat)

kernel_name = 'interleave_layers__mha_block_cached__dense_activation_gelu__decode'

def setup_inputs():

    _w = (lambda a: (lambda t: t.to(torch.bfloat16) if t.is_floating_point() else t)(torch.as_tensor(a)))
    def _A_setup():
        B, Sq, D = 1, 1, 512
        H, Sk, Dh = 32, 4096, 128
        return {
            "x": _w((lambda *s: torch.randn(*s, dtype=torch.bfloat16) * 0.05)(B, Sq, D)),
            "k_cache": _w((lambda *s: torch.randn(*s, dtype=torch.bfloat16) * 0.8)(B, H, Sk, Dh)),
            "v_cache": _w((lambda *s: torch.randn(*s, dtype=torch.bfloat16) * 1.6)(B, H, Sk, Dh)),
            "wq": _w((lambda *s: torch.randn(*s, dtype=torch.bfloat16) * 0.8)(D, H * Dh) * (D ** -0.5)),
            "wo": _w((lambda *s: torch.randn(*s, dtype=torch.bfloat16) * 1.6)(H * Dh, D) * ((H * Dh) ** -0.5)),
        }
    _A_in = _A_setup()

    def _B_setup():
        B, S, D, F = 1, 1, 512, 1376
        return {
            "x": _w((lambda *s: torch.randn(*s, dtype=torch.bfloat16) * 0.05)(B, S, D)),
            "w1": _w((lambda *s: torch.randn(*s, dtype=torch.bfloat16) * 0.4)(D, F) * (D ** -0.5)),
            "b1": _w((lambda *s: torch.randn(*s, dtype=torch.bfloat16) * 0.4)(F) * 0.01),
            "w2": _w((lambda *s: torch.randn(*s, dtype=torch.bfloat16) * 0.4)(F, D) * (F ** -0.5)),
            "b2": _w((lambda *s: torch.randn(*s, dtype=torch.bfloat16) * 0.4)(D) * 0.01),
        }
    _B_in = _B_setup()

    return {
        "A_x": _A_in["x"],
        "A_k_cache": _A_in["k_cache"],
        "A_v_cache": _A_in["v_cache"],
        "A_wq": _A_in["wq"],
        "A_wo": _A_in["wo"],
        "B_x": _B_in["x"],
        "B_w1": _B_in["w1"],
        "B_b1": _B_in["b1"],
        "B_w2": _B_in["w2"],
        "B_b2": _B_in["b2"],
    }

def reference(A_x, A_k_cache, A_v_cache, A_wq, A_wo, B_x, B_w1, B_b1, B_w2, B_b2):
    def _A_ref(x, k_cache, v_cache, wq, wo):
        B, Sq, D = x.shape
        H, Dh = 32, 128
        q = (lambda x, *d: x.permute(*d))((x @ wq).reshape(B, Sq, H, Dh), 0, 2, 1, 3)
        scores = torch.einsum("bhqd,bhkd->bhqk", q, k_cache) * (Dh ** -0.5)
        p = _softmax(scores, axis=-1)
        o = torch.einsum("bhqk,bhkd->bhqd", p, v_cache)
        return (lambda x, *d: x.permute(*d))(o, 0, 2, 1, 3).reshape(B, Sq, H * Dh) @ wo

    def _B_ref(x, w1, b1, w2, b2):
        h = torch.einsum("bsd,df->bsf", x, w1) + b1
        h = _gelu(h)
        return torch.einsum("bsf,fd->bsd", h, w2) + b2

    x = A_x
    x = x + _A_ref(_layernorm(x, axis=-1), A_k_cache, A_v_cache, A_wq, A_wo)
    x = x + _B_ref(_layernorm(x, axis=-1), B_w1, B_b1, B_w2, B_b2)
    x = x + _A_ref(_layernorm(x, axis=-1), A_k_cache, A_v_cache, A_wq, A_wo)
    x = x + _B_ref(_layernorm(x, axis=-1), B_w1, B_b1, B_w2, B_b2)
    return x
```

```asm
; @launch grid=(256,1,1) block=(512,1,1) lds=104448
.amdgcn_target "amdgcn-amd-amdhsa--gfx950"
.text
.globl interleave_layers__mha_block_cached__dense_activation_gelu__decode_kernel
.p2align 8
.type interleave_layers__mha_block_cached__dense_activation_gelu__decode_kernel,@function
interleave_layers__mha_block_cached__dense_activation_gelu__decode_kernel:
    s_cmp_ge_u32 s2, 256
    s_cbranch_scc1 L_END
    s_load_dwordx2 s[40:41], s[0:1], 24
    s_load_dwordx2 s[60:61], s[0:1], 0
    s_load_dwordx2 s[32:33], s[0:1], 8
    s_load_dwordx2 s[56:57], s[0:1], 96
    s_load_dwordx2 s[36:37], s[0:1], 16
    v_lshrrev_b32 v1, 6, v0
    s_and_b32 s80, s2, 7
    v_readfirstlane_b32 s85, v1
    s_lshr_b32 s81, s2, 3
    s_lshl_b32 s82, s80, 5
    s_add_u32 s82, s82, s81
    s_lshr_b32 s83, s82, 3
    s_and_b32 s84, s82, 7
    v_and_b32 v1, 63, v0
    v_and_b32 v2, 15, v0
    v_bfe_u32 v3, v0, 4, 2
    v_and_b32 v12, 3, v2
    v_lshlrev_b32 v12, 10, v12
    v_bfe_u32 v13, v2, 2, 1
    v_lshl_add_u32 v12, v13, 15, v12
    v_lshrrev_b32 v13, 3, v2
    v_lshl_add_u32 v12, v13, 6, v12
    v_lshl_add_u32 v4, v3, 4, v12
    v_lshlrev_b32 v5, 4, v1
    v_lshlrev_b32 v10, 2, v1
    s_lshl_b32 s91, s82, 17
    s_lshl_b32 s93, s85, 12
    s_add_u32 s91, s91, s93
    s_mov_b32 s34, 33554432
    s_mov_b32 s38, 33554432
    s_mov_b32 s42, 4194304
    s_mov_b32 s58, 268435456
    s_mov_b32 s62, 1024
    s_mov_b32 s46, 4194304
    s_mov_b32 s50, 1409024
    s_mov_b32 s54, 1409024
    s_mov_b32 s66, 2752
    s_mov_b32 s70, 1024
    s_mov_b32 s74, 1024
    s_mov_b32 s35, 0x20000
    s_mov_b32 s39, 0x20000
    s_mov_b32 s43, 0x20000
    s_mov_b32 s47, 0x20000
    s_mov_b32 s51, 0x20000
    s_mov_b32 s55, 0x20000
    s_mov_b32 s59, 0x20000
    s_mov_b32 s63, 0x20000
    s_mov_b32 s67, 0x20000
    s_mov_b32 s71, 0x20000
    s_mov_b32 s75, 0x20000
    s_mov_b32 s79, 0x20000
    v_mov_b32 v11, 0
    v_lshlrev_b32 v16, 13, v3
    v_lshl_add_u32 v16, v2, 4, v16
    s_lshl_b32 s93, s84, 19
    s_lshl_b32 s94, s83, 8
    s_add_u32 s93, s93, s94
    v_lshlrev_b32 v17, 4, v3
    s_lshl_b32 s94, s84, 7
    v_mov_b32 v18, 561152
    s_waitcnt lgkmcnt(0)
    s_load_dwordx2 s[44:45], s[0:1], 32
    s_load_dwordx2 s[48:49], s[0:1], 48
    s_load_dwordx2 s[52:53], s[0:1], 64
    s_load_dwordx2 s[64:65], s[0:1], 56
    s_load_dwordx2 s[68:69], s[0:1], 72
    s_load_dwordx2 s[72:73], s[0:1], 80
    s_cmp_lg_u32 s85, 0
    s_cbranch_scc1 L_NOTW0
    buffer_load_dwordx2 v[248:249], v18, s[56:59], 0 offen sc1
    s_mov_b32 m0, 20480
    s_nop 0
    buffer_load_dwordx4 v16, s[40:43], s93 offen nt lds
    s_add_u32 s93, s93, 32768
    s_mov_b32 m0, 21504
    s_nop 0
    buffer_load_dwordx4 v16, s[40:43], s93 offen nt lds
    s_add_u32 s93, s93, 32768
    s_mov_b32 m0, 22528
    s_nop 0
    buffer_load_dwordx4 v16, s[40:43], s93 offen nt lds
    s_add_u32 s93, s93, 32768
    s_mov_b32 m0, 23552
    s_nop 0
    buffer_load_dwordx4 v16, s[40:43], s93 offen nt lds
    s_add_u32 s93, s93, 32768
    s_mov_b32 m0, 24576
    s_nop 0
    buffer_load_dwordx4 v16, s[40:43], s93 offen nt lds
    s_add_u32 s93, s93, 32768
    s_mov_b32 m0, 25600
    s_nop 0
    buffer_load_dwordx4 v16, s[40:43], s93 offen nt lds
    s_add_u32 s93, s93, 32768
    s_mov_b32 m0, 26624
    s_nop 0
    buffer_load_dwordx4 v16, s[40:43], s93 offen nt lds
    s_add_u32 s93, s93, 32768
    s_mov_b32 m0, 27648
    s_nop 0
    buffer_load_dwordx4 v16, s[40:43], s93 offen nt lds
    s_add_u32 s93, s93, 32768
    s_mov_b32 m0, 28672
    s_nop 0
    buffer_load_dwordx4 v16, s[40:43], s93 offen nt lds
    s_add_u32 s93, s93, 32768
    s_mov_b32 m0, 29696
    s_nop 0
    buffer_load_dwordx4 v16, s[40:43], s93 offen nt lds
    s_add_u32 s93, s93, 32768
    s_mov_b32 m0, 30720
    s_nop 0
    buffer_load_dwordx4 v16, s[40:43], s93 offen nt lds
    s_add_u32 s93, s93, 32768
    s_mov_b32 m0, 31744
    s_nop 0
    buffer_load_dwordx4 v16, s[40:43], s93 offen nt lds
    s_add_u32 s93, s93, 32768
    s_mov_b32 m0, 32768
    s_nop 0
    buffer_load_dwordx4 v16, s[40:43], s93 offen nt lds
    s_add_u32 s93, s93, 32768
    s_mov_b32 m0, 33792
    s_nop 0
    buffer_load_dwordx4 v16, s[40:43], s93 offen nt lds
    s_add_u32 s93, s93, 32768
    s_mov_b32 m0, 34816
    s_nop 0
    buffer_load_dwordx4 v16, s[40:43], s93 offen nt lds
    s_add_u32 s93, s93, 32768
    s_mov_b32 m0, 35840
    s_nop 0
    buffer_load_dwordx4 v16, s[40:43], s93 offen nt lds
    s_add_u32 s93, s93, 32768
    buffer_load_dwordx4 v[20:23], v17, s[60:63], s94 offen
    buffer_load_dwordx4 v[24:27], v17, s[60:63], s94 offen offset:64
    buffer_load_dwordx4 v[28:31], v5, s[60:63], 0 offen
    s_add_u32 s93, s91, 0
    buffer_load_dwordx4 v[32:35], v4, s[32:35], s93 offen offset:0 nt
    buffer_load_dwordx4 v[36:39], v4, s[32:35], s93 offen offset:128 nt
    buffer_load_dwordx4 v[64:67], v4, s[32:35], s93 offen offset:256 nt
    buffer_load_dwordx4 v[68:71], v4, s[32:35], s93 offen offset:384 nt
    buffer_load_dwordx4 v[40:43], v4, s[32:35], s93 offen offset:512 nt
    buffer_load_dwordx4 v[44:47], v4, s[32:35], s93 offen offset:640 nt
    buffer_load_dwordx4 v[72:75], v4, s[32:35], s93 offen offset:768 nt
    buffer_load_dwordx4 v[76:79], v4, s[32:35], s93 offen offset:896 nt
    s_add_u32 s93, s91, 65536
    buffer_load_dwordx4 v[48:51], v4, s[32:35], s93 offen offset:0 nt
    buffer_load_dwordx4 v[52:55], v4, s[32:35], s93 offen offset:128 nt
    buffer_load_dwordx4 v[80:83], v4, s[32:35], s93 offen offset:256 nt
    buffer_load_dwordx4 v[84:87], v4, s[32:35], s93 offen offset:384 nt
    buffer_load_dwordx4 v[56:59], v4, s[32:35], s93 offen offset:512 nt
    buffer_load_dwordx4 v[60:63], v4, s[32:35], s93 offen offset:640 nt
    buffer_load_dwordx4 v[88:91], v4, s[32:35], s93 offen offset:768 nt
    buffer_load_dwordx4 v[92:95], v4, s[32:35], s93 offen offset:896 nt
    s_mov_b32 s32, s56
    s_mov_b32 s33, s57
    s_mov_b32 s34, 0x10000000
    v_bfe_u32 v4, v2, 1, 1
    v_mul_u32_u24 v4, 0xaaaa, v4
    v_add_u32 v4, 0x4444, v4
    s_add_u32 s93, s91, 0
    buffer_load_dwordx4 v[100:103], v5, s[36:39], s93 offen offset:0 nt
    s_add_u32 s93, s91, 0
    buffer_load_dwordx4 v[108:111], v5, s[36:39], s93 offen offset:1024 nt
    s_add_u32 s93, s91, 0
    buffer_load_dwordx4 v[116:119], v5, s[36:39], s93 offen offset:2048 nt
    s_add_u32 s93, s91, 0
    buffer_load_dwordx4 v[124:127], v5, s[36:39], s93 offen offset:3072 nt
    s_add_u32 s93, s91, 32768
    buffer_load_dwordx4 v[132:135], v5, s[36:39], s93 offen offset:0 nt
    s_add_u32 s93, s91, 32768
    buffer_load_dwordx4 v[140:143], v5, s[36:39], s93 offen offset:1024 nt
    s_add_u32 s93, s91, 32768
    buffer_load_dwordx4 v[148:151], v5, s[36:39], s93 offen offset:2048 nt
    s_add_u32 s93, s91, 32768
    buffer_load_dwordx4 v[156:159], v5, s[36:39], s93 offen offset:3072 nt
    s_add_u32 s93, s91, 65536
    buffer_load_dwordx4 v[160:163], v5, s[36:39], s93 offen offset:0 nt
    s_add_u32 s93, s91, 65536
    buffer_load_dwordx4 v[164:167], v5, s[36:39], s93 offen offset:1024 nt
    s_add_u32 s93, s91, 65536
    buffer_load_dwordx4 v[168:171], v5, s[36:39], s93 offen offset:2048 nt
    s_add_u32 s93, s91, 65536
    buffer_load_dwordx4 v[172:175], v5, s[36:39], s93 offen offset:3072 nt
    s_add_u32 s93, s91, 98304
    buffer_load_dwordx4 v[176:179], v5, s[36:39], s93 offen offset:0 nt
    s_add_u32 s93, s91, 98304
    buffer_load_dwordx4 v[180:183], v5, s[36:39], s93 offen offset:1024 nt
    s_add_u32 s93, s91, 98304
    buffer_load_dwordx4 v[184:187], v5, s[36:39], s93 offen offset:2048 nt
    s_add_u32 s93, s91, 98304
    buffer_load_dwordx4 v[188:191], v5, s[36:39], s93 offen offset:3072 nt
    s_barrier
    s_cmp_lt_u32 s81, 16
    s_cselect_b32 s87, 1, 0
    s_min_u32 s86, s80, 3
    s_mul_i32 s93, s80, 5
    s_add_u32 s86, s86, s93
    s_add_u32 s86, s86, s81
    s_sub_u32 s86, s86, 16
    s_cmp_lt_u32 s80, 3
    s_cselect_b32 s93, 6, 5
    s_sub_u32 s94, s81, 16
    s_cmp_lt_u32 s94, s93
    s_cselect_b32 s88, 1, 0
    s_cselect_b32 s86, s86, 0
    s_or_b32 s31, s87, s88
    s_mov_b32 s90, 0
    s_mov_b32 s92, 0
    s_mov_b32 s14, 0x05040100
    s_mov_b32 s15, 0x07060302
    s_mov_b32 s30, 0x3e0293ee
    s_mov_b64 s[4:5], 0xffff
    s_mov_b32 s6, 0
    s_mov_b32 s7, -1
    s_mov_b32 s10, 0
    s_mov_b32 s11, 0xffff0000
    s_mov_b32 s16, 0xffff0000
    s_mov_b32 s17, 0xffff0000
    s_mov_b32 s20, 0xff00ff00
    s_mov_b32 s21, 0xff00ff00
    s_mov_b32 s97, 1
    s_mov_b32 s98, 2
    s_mov_b32 s76, s56
    s_mov_b32 s77, s57
    s_mov_b32 s78, 0
    s_lshl_b32 s100, s85, 12
    v_lshrrev_b32 v12, 2, v2
    v_lshl_add_u32 v12, v3, 3, v12
    v_and_b32 v13, 3, v2
    v_lshlrev_b32 v13, 3, v13
    v_lshl_add_u32 v6, v12, 6, v13
    v_lshl_add_u32 v7, v12, 7, v13
    v_lshl_add_u32 v8, v12, 8, v13
    v_add_u32 v6, s100, v6
    v_add_u32 v7, s100, v7
    v_bfe_u32 v12, v2, 1, 1
    v_lshlrev_b32 v12, 4, v12
    v_lshl_add_u32 v12, v3, 5, v12
    s_lshl_b32 s93, s85, 7
    s_add_u32 s93, s93, 18432
    v_add_u32 v9, s93, v12
    v_bfe_u32 v13, v2, 2, 2
    v_lshl_add_u32 v13, v13, 2, v9
    v_and_b32 v14, 1, v2
    v_lshl_add_u32 v255, v14, 1, v13
    s_mov_b32 s25, 0x7f800000
    s_mov_b32 s3, 0
    s_lshl_b32 s43, s83, 12
    s_lshl_b32 s94, s84, 4
    s_add_u32 s12, s43, s94
    s_add_u32 s12, s12, 262144
    s_lshl_b32 s13, s83, 6
    s_and_b32 s94, s84, 3
    s_lshl_b32 s94, s94, 4
    s_add_u32 s13, s13, s94
    s_lshr_b32 s94, s84, 2
    s_lshl_b32 s94, s94, 3
    s_add_u32 s13, s13, s94
    s_add_u32 s13, s13, 395264
    s_lshl_b32 s24, s82, 2
    s_add_u32 s24, s24, 397312
    s_lshl_b32 s29, s80, 14
    s_lshl_b32 s94, s85, 11
    s_add_u32 s29, s29, s94
    s_add_u32 s29, s29, 262144
    s_lshr_b32 s93, s85, 1
    s_lshl_b32 s94, s80, 2
    s_add_u32 s93, s93, s94
    s_lshl_b32 s41, s93, 5
    s_add_u32 s41, s41, 397312
    s_lshl_b32 s40, s93, 6
    s_add_u32 s40, s40, 395264
    s_lshr_b32 s42, s81, 3
    s_lshl_b32 s42, s42, 14
    s_and_b32 s94, s81, 6
    s_lshl_b32 s94, s94, 10
    s_add_u32 s42, s42, s94
    s_lshl_b32 s94, s80, 8
    s_add_u32 s42, s42, s94
    s_and_b32 s94, s81, 1
    s_lshl_b32 s94, s94, 7
    s_add_u32 s42, s42, s94
    s_add_u32 s42, s42, 409600
    s_branch L_SVC
L_NOTW0:
    s_cmp_lg_u32 s85, 1
    s_cbranch_scc1 L_NOTW1
    buffer_load_dwordx2 v[248:249], v18, s[56:59], 0 offen sc1
    v_mov_b32 v17, 0
    ds_write_b32 v10, v17 offset:256
    v_mov_b32 v17, 0x7f800000
    v_lshlrev_b32 v19, 5, v1
    ds_write_b32 v19, v17 offset:16384
    s_cmp_lt_u32 s81, 28
    s_cbranch_scc1 NOCLR_1
    v_mov_b32 v12, -1
    v_mov_b32 v13, -1
    v_mov_b32 v14, -1
    v_mov_b32 v15, -1
    s_lshl_b32 s93, s80, 2
    s_add_u32 s93, s93, s81
    s_lshl_b32 s93, s93, 13
    s_add_u32 s93, s93, 32768
    s_add_u32 s94, s93, 4096
    buffer_store_dwordx4 v[12:15], v5, s[56:59], s93 offen offset:0 sc1
    buffer_store_dwordx4 v[12:15], v5, s[56:59], s93 offen offset:1024 sc1
    buffer_store_dwordx4 v[12:15], v5, s[56:59], s93 offen offset:2048 sc1
    buffer_store_dwordx4 v[12:15], v5, s[56:59], s93 offen offset:3072 sc1
    buffer_store_dwordx4 v[12:15], v5, s[56:59], s94 offen offset:0 sc1
    buffer_store_dwordx4 v[12:15], v5, s[56:59], s94 offen offset:1024 sc1
    buffer_store_dwordx4 v[12:15], v5, s[56:59], s94 offen offset:2048 sc1
    buffer_store_dwordx4 v[12:15], v5, s[56:59], s94 offen offset:3072 sc1
NOCLR_1:
    s_nop 0
    s_branch L_CONST
L_NOTW1:
    s_cmp_lg_u32 s85, 2
    s_cbranch_scc1 NOPF_2
    s_lshr_b32 s93, s81, 0
    s_cmp_lg_u32 s93, 31
    s_cbranch_scc1 NOPF_2
    s_getpc_b64 s[12:13]
L_PC:
    v_mov_b32 v16, v5
    v_min_u32 v17, L_END-L_PC-12, v16
    global_load_dwordx4 v[240:243], v17, s[12:13]
    v_add_u32 v16, 1024, v16
    v_min_u32 v17, L_END-L_PC-12, v16
    global_load_dwordx4 v[240:243], v17, s[12:13]
    v_add_u32 v16, 1024, v16
    v_min_u32 v17, L_END-L_PC-12, v16
    global_load_dwordx4 v[240:243], v17, s[12:13]
    v_add_u32 v16, 1024, v16
    v_min_u32 v17, L_END-L_PC-12, v16
    global_load_dwordx4 v[240:243], v17, s[12:13]
    v_add_u32 v16, 1024, v16
    v_min_u32 v17, L_END-L_PC-12, v16
    global_load_dwordx4 v[240:243], v17, s[12:13]
    v_add_u32 v16, 1024, v16
    v_min_u32 v17, L_END-L_PC-12, v16
    global_load_dwordx4 v[240:243], v17, s[12:13]
    v_add_u32 v16, 1024, v16
    v_min_u32 v17, L_END-L_PC-12, v16
    global_load_dwordx4 v[240:243], v17, s[12:13]
    v_add_u32 v16, 1024, v16
    v_min_u32 v17, L_END-L_PC-12, v16
    global_load_dwordx4 v[240:243], v17, s[12:13]
    v_add_u32 v16, 1024, v16
    v_min_u32 v17, L_END-L_PC-12, v16
    global_load_dwordx4 v[240:243], v17, s[12:13]
    v_add_u32 v16, 1024, v16
    v_min_u32 v17, L_END-L_PC-12, v16
    global_load_dwordx4 v[240:243], v17, s[12:13]
    v_add_u32 v16, 1024, v16
    v_min_u32 v17, L_END-L_PC-12, v16
    global_load_dwordx4 v[240:243], v17, s[12:13]
    v_add_u32 v16, 1024, v16
    v_min_u32 v17, L_END-L_PC-12, v16
    global_load_dwordx4 v[240:243], v17, s[12:13]
    v_add_u32 v16, 1024, v16
    v_min_u32 v17, L_END-L_PC-12, v16
    global_load_dwordx4 v[240:243], v17, s[12:13]
    v_add_u32 v16, 1024, v16
    v_min_u32 v17, L_END-L_PC-12, v16
    global_load_dwordx4 v[240:243], v17, s[12:13]
    v_add_u32 v16, 1024, v16
    v_min_u32 v17, L_END-L_PC-12, v16
    global_load_dwordx4 v[240:243], v17, s[12:13]
    v_add_u32 v16, 1024, v16
    v_min_u32 v17, L_END-L_PC-12, v16
    global_load_dwordx4 v[240:243], v17, s[12:13]
    v_add_u32 v16, 1024, v16
    v_min_u32 v17, L_END-L_PC-12, v16
    global_load_dwordx4 v[240:243], v17, s[12:13]
    v_add_u32 v16, 1024, v16
NOPF_2:
L_CONST:
    s_cmp_lt_u32 s81, 16
    s_cselect_b32 s87, 1, 0
    s_min_u32 s86, s80, 3
    s_mul_i32 s93, s80, 5
    s_add_u32 s86, s86, s93
    s_add_u32 s86, s86, s81
    s_sub_u32 s86, s86, 16
    s_cmp_lt_u32 s80, 3
    s_cselect_b32 s93, 6, 5
    s_sub_u32 s94, s81, 16
    s_cmp_lt_u32 s94, s93
    s_cselect_b32 s88, 1, 0
    s_cselect_b32 s86, s86, 0
    s_or_b32 s31, s87, s88
    s_mov_b32 s90, 0
    s_mov_b32 s92, 0
    s_mov_b32 s14, 0x05040100
    s_mov_b32 s15, 0x07060302
    s_mov_b32 s30, 0x3e0293ee
    s_mov_b64 s[4:5], 0xffff
    s_mov_b32 s6, 0
    s_mov_b32 s7, -1
    s_mov_b32 s10, 0
    s_mov_b32 s11, 0xffff0000
    s_mov_b32 s16, 0xffff0000
    s_mov_b32 s17, 0xffff0000
    s_mov_b32 s20, 0xff00ff00
    s_mov_b32 s21, 0xff00ff00
    s_mov_b32 s97, 1
    s_mov_b32 s98, 2
    s_mov_b32 s76, s56
    s_mov_b32 s77, s57
    s_mov_b32 s78, 0
    s_lshl_b32 s100, s85, 12
    v_lshrrev_b32 v12, 2, v2
    v_lshl_add_u32 v12, v3, 3, v12
    v_and_b32 v13, 3, v2
    v_lshlrev_b32 v13, 3, v13
    v_lshl_add_u32 v6, v12, 6, v13
    v_lshl_add_u32 v7, v12, 7, v13
    v_lshl_add_u32 v8, v12, 8, v13
    v_add_u32 v6, s100, v6
    v_add_u32 v7, s100, v7
    v_bfe_u32 v12, v2, 1, 1
    v_lshlrev_b32 v12, 4, v12
    v_lshl_add_u32 v12, v3, 5, v12
    s_lshl_b32 s93, s85, 7
    s_add_u32 s93, s93, 18432
    v_add_u32 v9, s93, v12
    v_bfe_u32 v13, v2, 2, 2
    v_lshl_add_u32 v13, v13, 2, v9
    v_and_b32 v14, 1, v2
    v_lshl_add_u32 v255, v14, 1, v13
    s_mov_b32 s25, 0x7f800000
    s_mov_b32 s3, 0
    s_lshl_b32 s43, s83, 12
    s_lshl_b32 s94, s84, 4
    s_add_u32 s12, s43, s94
    s_add_u32 s12, s12, 262144
    s_lshl_b32 s13, s83, 6
    s_and_b32 s94, s84, 3
    s_lshl_b32 s94, s94, 4
    s_add_u32 s13, s13, s94
    s_lshr_b32 s94, s84, 2
    s_lshl_b32 s94, s94, 3
    s_add_u32 s13, s13, s94
    s_add_u32 s13, s13, 395264
    s_lshl_b32 s24, s82, 2
    s_add_u32 s24, s24, 397312
    s_lshl_b32 s29, s80, 14
    s_lshl_b32 s94, s85, 11
    s_add_u32 s29, s29, s94
    s_add_u32 s29, s29, 262144
    s_lshr_b32 s93, s85, 1
    s_lshl_b32 s94, s80, 2
    s_add_u32 s93, s93, s94
    s_lshl_b32 s41, s93, 5
    s_add_u32 s41, s41, 397312
    s_lshl_b32 s40, s93, 6
    s_add_u32 s40, s40, 395264
    s_lshr_b32 s42, s81, 3
    s_lshl_b32 s42, s42, 14
    s_and_b32 s94, s81, 6
    s_lshl_b32 s94, s94, 10
    s_add_u32 s42, s42, s94
    s_lshl_b32 s94, s80, 8
    s_add_u32 s42, s42, s94
    s_and_b32 s94, s81, 1
    s_lshl_b32 s94, s94, 7
    s_add_u32 s42, s42, s94
    s_add_u32 s42, s42, 409600
    v_mov_b32 v224, 0
    v_mov_b32 v225, 0
    v_mov_b32 v226, 0
    v_mov_b32 v227, 0
    v_mov_b32 v228, 0
    v_mov_b32 v229, 0
    v_mov_b32 v230, 0
    v_mov_b32 v231, 0
    v_mov_b32 v232, 0
    v_mov_b32 v234, 0
    v_mov_b32 v236, 0
    v_mov_b32 v238, 0
    v_mov_b32 v192, 0
    v_mov_b32 v193, 0
    v_mov_b32 v194, 0
    v_mov_b32 v195, 0
    v_mov_b32 v196, 0
    v_mov_b32 v197, 0
    v_mov_b32 v198, 0
    v_mov_b32 v199, 0
    v_mov_b32 v200, 0
    v_mov_b32 v201, 0
    v_mov_b32 v202, 0
    v_mov_b32 v203, 0
    v_mov_b32 v204, 0
    v_mov_b32 v205, 0
    v_mov_b32 v206, 0
    v_mov_b32 v207, 0
    v_and_b32 v16, 1, v2
    v_lshlrev_b32 v16, 7, v16
    v_bfe_u32 v17, v2, 1, 1
    v_lshl_add_u32 v16, v17, 6, v16
    v_lshl_add_u32 v16, v3, 4, v16
    v_lshrrev_b32 v17, 2, v2
    v_mov_b32 v18, 288
    v_cmp_eq_u32 vcc, 0, v17
    s_nop 1
    v_cndmask_b32 v12, v18, v16, vcc
    v_cmp_eq_u32 vcc, 1, v17
    s_nop 1
    v_cndmask_b32 v13, v18, v16, vcc
    v_cmp_eq_u32 vcc, 2, v17
    s_nop 1
    v_cndmask_b32 v14, v18, v16, vcc
    v_cmp_eq_u32 vcc, 3, v17
    s_nop 1
    v_cndmask_b32 v15, v18, v16, vcc
    s_lshl_b32 s93, s85, 9
    v_lshl_add_u32 v31, v2, 5, s93
    v_lshl_add_u32 v31, v3, 3, v31
    s_lshl_b32 s93, s85, 8
    v_add_u32 v29, s93, v10
    v_lshlrev_b32 v27, 3, v1
    v_and_b32 v28, 7, v1
    v_lshlrev_b32 v28, 8, v28
    v_and_b32 v16, 12, v10
    v_lshrrev_b32 v17, 2, v1
    v_lshl_add_u32 v30, v17, 8, v16
    s_waitcnt lgkmcnt(0)
    s_barrier
    s_cmp_lg_u32 s85, 1
    s_cbranch_scc1 L_BULK
    s_waitcnt vmcnt(0)
    v_readfirstlane_b32 s28, v248
    v_readfirstlane_b32 s96, v249
    s_getreg_b32 s95, hwreg(HW_REG_XCC_ID, 0, 4)
    s_add_u32 s28, s28, 1
    s_and_b32 s96, s96, 0xffffff00
    s_or_b32 s95, s95, s96
    v_mov_b32 v18, s28
    v_mov_b32 v19, s95
    s_lshl_b32 s93, s82, 7
    s_add_u32 s93, s93, 524288
    v_mov_b32 v17, s93
    s_lshl_b32 s93, s80, 2
    s_add_u32 s93, s93, s81
    s_lshl_b32 s93, s93, 7
    s_add_u32 s93, s93, 553472
    s_cmp_ge_u32 s81, 28
    s_cselect_b32 s93, s93, 268435456
    v_writelane_b32 v17, s93, 1
    s_mov_b64 exec, 3
    buffer_store_dwordx2 v[18:19], v17, s[56:59], 0 offen sc1
    s_mov_b64 exec, -1
L_BULK:
    s_add_u32 s93, s91, 0
    buffer_load_dwordx4 v[32:35], v4, s[32:35], s93 offen offset:0 nt
    buffer_load_dwordx4 v[36:39], v4, s[32:35], s93 offen offset:128 nt
    buffer_load_dwordx4 v[64:67], v4, s[32:35], s93 offen offset:256 nt
    buffer_load_dwordx4 v[68:71], v4, s[32:35], s93 offen offset:384 nt
    buffer_load_dwordx4 v[40:43], v4, s[32:35], s93 offen offset:512 nt
    s_waitcnt vmcnt(4)
    buffer_load_dwordx4 v[44:47], v4, s[32:35], s93 offen offset:640 nt
    s_waitcnt vmcnt(4)
    buffer_load_dwordx4 v[72:75], v4, s[32:35], s93 offen offset:768 nt
    s_waitcnt vmcnt(4)
    buffer_load_dwordx4 v[76:79], v4, s[32:35], s93 offen offset:896 nt
    s_add_u32 s93, s91, 65536
    s_waitcnt vmcnt(4)
    buffer_load_dwordx4 v[48:51], v4, s[32:35], s93 offen offset:0 nt
    s_cmp_lg_u32 s85, 7
    s_cbranch_scc1 NT_3
    v_mov_b32 v17, 0
    v_mov_b32 v18, 1
    ds_write_b32 v17, v18 offset:272
NT_3:
    s_waitcnt vmcnt(4)
    buffer_load_dwordx4 v[52:55], v4, s[32:35], s93 offen offset:128 nt
    s_waitcnt vmcnt(4)
    buffer_load_dwordx4 v[80:83], v4, s[32:35], s93 offen offset:256 nt
    s_waitcnt vmcnt(4)
    buffer_load_dwordx4 v[84:87], v4, s[32:35], s93 offen offset:384 nt
    s_waitcnt vmcnt(4)
    buffer_load_dwordx4 v[56:59], v4, s[32:35], s93 offen offset:512 nt
    s_waitcnt vmcnt(4)
    buffer_load_dwordx4 v[60:63], v4, s[32:35], s93 offen offset:640 nt
    s_cmp_lg_u32 s85, 7
    s_cbranch_scc1 NT_4
    v_mov_b32 v17, 0
    v_mov_b32 v18, 2
    ds_write_b32 v17, v18 offset:272
NT_4:
    s_waitcnt vmcnt(4)
    buffer_load_dwordx4 v[88:91], v4, s[32:35], s93 offen offset:768 nt
    s_waitcnt vmcnt(4)
    buffer_load_dwordx4 v[92:95], v4, s[32:35], s93 offen offset:896 nt
    s_mov_b32 s32, s56
    s_mov_b32 s33, s57
    s_mov_b32 s34, 0x10000000
    v_bfe_u32 v4, v2, 1, 1
    v_mul_u32_u24 v4, 0xaaaa, v4
    v_add_u32 v4, 0x4444, v4
    s_add_u32 s93, s91, 0
    s_waitcnt vmcnt(4)
    buffer_load_dwordx4 v[100:103], v5, s[36:39], s93 offen offset:0 nt
    s_add_u32 s93, s91, 0
    s_waitcnt vmcnt(4)
    buffer_load_dwordx4 v[108:111], v5, s[36:39], s93 offen offset:1024 nt
    s_add_u32 s93, s91, 0
    s_waitcnt vmcnt(4)
    buffer_load_dwordx4 v[116:119], v5, s[36:39], s93 offen offset:2048 nt
    s_add_u32 s93, s91, 0
    s_waitcnt vmcnt(4)
    buffer_load_dwordx4 v[124:127], v5, s[36:39], s93 offen offset:3072 nt
    s_add_u32 s93, s91, 32768
    s_waitcnt vmcnt(4)
    buffer_load_dwordx4 v[132:135], v5, s[36:39], s93 offen offset:0 nt
    s_add_u32 s93, s91, 32768
    s_waitcnt vmcnt(4)
    buffer_load_dwordx4 v[140:143], v5, s[36:39], s93 offen offset:1024 nt
    s_add_u32 s93, s91, 32768
    s_waitcnt vmcnt(4)
    buffer_load_dwordx4 v[148:151], v5, s[36:39], s93 offen offset:2048 nt
    s_add_u32 s93, s91, 32768
    s_waitcnt vmcnt(4)
    buffer_load_dwordx4 v[156:159], v5, s[36:39], s93 offen offset:3072 nt
    s_add_u32 s93, s91, 65536
    buffer_load_dwordx4 v[160:163], v5, s[36:39], s93 offen offset:0 nt
    s_add_u32 s93, s91, 65536
    buffer_load_dwordx4 v[164:167], v5, s[36:39], s93 offen offset:1024 nt
    s_add_u32 s93, s91, 65536
    buffer_load_dwordx4 v[168:171], v5, s[36:39], s93 offen offset:2048 nt
    s_add_u32 s93, s91, 65536
    buffer_load_dwordx4 v[172:175], v5, s[36:39], s93 offen offset:3072 nt
    s_branch L_QBAR
L_SVC:
    s_setprio 3
    v_mov_b32 v15, 0x3f803f80
    s_waitcnt vmcnt(32)
    v_cmp_eq_u32 vcc, 1, v2
    s_nop 1
    v_cndmask_b32 v20, v20, v15, vcc
    v_cndmask_b32 v21, v21, v15, vcc
    v_cndmask_b32 v22, v22, v15, vcc
    v_cndmask_b32 v23, v23, v15, vcc
    v_cndmask_b32 v24, v24, v15, vcc
    v_cndmask_b32 v25, v25, v15, vcc
    v_cndmask_b32 v26, v26, v15, vcc
    v_cndmask_b32 v27, v27, v15, vcc
    v_mov_b32 v16, 0
    v_mov_b32 v17, 0
    ds_read_b64_tr_b16 v[224:225], v8 offset:20480
    ds_read_b64_tr_b16 v[226:227], v8 offset:21504
    ds_read_b64_tr_b16 v[228:229], v8 offset:28672
    ds_read_b64_tr_b16 v[230:231], v8 offset:29696
    ds_read_b64_tr_b16 v[232:233], v8 offset:20512
    ds_read_b64_tr_b16 v[234:235], v8 offset:21536
    ds_read_b64_tr_b16 v[236:237], v8 offset:28704
    ds_read_b64_tr_b16 v[238:239], v8 offset:29728
    v_dot2_f32_bf16 v16, v28, v28, v16
    v_dot2_f32_bf16 v17, v28, v15, v17
    s_waitcnt lgkmcnt(0)
    v_mfma_f32_16x16x32_bf16 v[192:195], v[20:23], v[224:227], 0
    v_mfma_f32_16x16x32_bf16 v[192:195], v[24:27], v[228:231], v[192:195]
    v_mfma_f32_16x16x32_bf16 v[196:199], v[20:23], v[232:235], 0
    v_mfma_f32_16x16x32_bf16 v[196:199], v[24:27], v[236:239], v[196:199]
    s_nop 3
    ds_read_b64_tr_b16 v[224:225], v8 offset:20544
    ds_read_b64_tr_b16 v[226:227], v8 offset:21568
    ds_read_b64_tr_b16 v[228:229], v8 offset:28736
    ds_read_b64_tr_b16 v[230:231], v8 offset:29760
    ds_read_b64_tr_b16 v[232:233], v8 offset:20576
    ds_read_b64_tr_b16 v[234:235], v8 offset:21600
    ds_read_b64_tr_b16 v[236:237], v8 offset:28768
    ds_read_b64_tr_b16 v[238:239], v8 offset:29792
    v_dot2_f32_bf16 v16, v29, v29, v16
    v_dot2_f32_bf16 v17, v29, v15, v17
    s_waitcnt lgkmcnt(0)
    v_mfma_f32_16x16x32_bf16 v[200:203], v[20:23], v[224:227], 0
    v_mfma_f32_16x16x32_bf16 v[200:203], v[24:27], v[228:231], v[200:203]
    v_mfma_f32_16x16x32_bf16 v[204:207], v[20:23], v[232:235], 0
    v_mfma_f32_16x16x32_bf16 v[204:207], v[24:27], v[236:239], v[204:207]
    s_nop 3
    ds_read_b64_tr_b16 v[224:225], v8 offset:20608
    ds_read_b64_tr_b16 v[226:227], v8 offset:21632
    ds_read_b64_tr_b16 v[228:229], v8 offset:28800
    ds_read_b64_tr_b16 v[230:231], v8 offset:29824
    ds_read_b64_tr_b16 v[232:233], v8 offset:20640
    ds_read_b64_tr_b16 v[234:235], v8 offset:21664
    ds_read_b64_tr_b16 v[236:237], v8 offset:28832
    ds_read_b64_tr_b16 v[238:239], v8 offset:29856
    v_dot2_f32_bf16 v16, v30, v30, v16
    v_dot2_f32_bf16 v17, v30, v15, v17
    s_waitcnt lgkmcnt(0)
    v_mfma_f32_16x16x32_bf16 v[208:211], v[20:23], v[224:227], 0
    v_mfma_f32_16x16x32_bf16 v[208:211], v[24:27], v[228:231], v[208:211]
    v_mfma_f32_16x16x32_bf16 v[212:215], v[20:23], v[232:235], 0
    v_mfma_f32_16x16x32_bf16 v[212:215], v[24:27], v[236:239], v[212:215]
    s_nop 3
    ds_read_b64_tr_b16 v[224:225], v8 offset:20672
    ds_read_b64_tr_b16 v[226:227], v8 offset:21696
    ds_read_b64_tr_b16 v[228:229], v8 offset:28864
    ds_read_b64_tr_b16 v[230:231], v8 offset:29888
    ds_read_b64_tr_b16 v[232:233], v8 offset:20704
    ds_read_b64_tr_b16 v[234:235], v8 offset:21728
    ds_read_b64_tr_b16 v[236:237], v8 offset:28896
    ds_read_b64_tr_b16 v[238:239], v8 offset:29920
    v_dot2_f32_bf16 v16, v31, v31, v16
    v_dot2_f32_bf16 v17, v31, v15, v17
    s_waitcnt lgkmcnt(0)
    v_mfma_f32_16x16x32_bf16 v[216:219], v[20:23], v[224:227], 0
    v_mfma_f32_16x16x32_bf16 v[216:219], v[24:27], v[228:231], v[216:219]
    v_mfma_f32_16x16x32_bf16 v[220:223], v[20:23], v[232:235], 0
    v_mfma_f32_16x16x32_bf16 v[220:223], v[24:27], v[236:239], v[220:223]
    s_nop 3
    v_add_f32_dpp v16, v16, v16 quad_perm:[1,0,3,2] row_mask:0xf bank_mask:0xf
    v_add_f32_dpp v17, v17, v17 quad_perm:[1,0,3,2] row_mask:0xf bank_mask:0xf
    s_nop 0
    v_add_f32_dpp v16, v16, v16 quad_perm:[2,3,0,1] row_mask:0xf bank_mask:0xf
    v_add_f32_dpp v17, v17, v17 quad_perm:[2,3,0,1] row_mask:0xf bank_mask:0xf
    s_nop 0
    v_add_f32_dpp v16, v16, v16 row_half_mirror row_mask:0xf bank_mask:0xf
    v_add_f32_dpp v17, v17, v17 row_half_mirror row_mask:0xf bank_mask:0xf
    s_nop 0
    v_add_f32_dpp v16, v16, v16 row_mirror row_mask:0xf bank_mask:0xf
    v_add_f32_dpp v17, v17, v17 row_mirror row_mask:0xf bank_mask:0xf
    v_mov_b32 v18, v16
    v_mov_b32 v19, v17
    s_nop 0
    v_permlane16_swap_b32 v16, v18
    v_permlane16_swap_b32 v17, v19
    v_add_f32 v16, v16, v18
    v_add_f32 v17, v17, v19
    v_mov_b32 v18, v16
    v_mov_b32 v19, v17
    s_nop 0
    v_permlane32_swap_b32 v16, v18
    v_permlane32_swap_b32 v17, v19
    v_add_f32 v16, v16, v18
    v_add_f32 v17, v17, v19
    v_mul_f32 v17, 0x3b000000, v17
    v_mul_f32 v16, 0x3b000000, v16
    v_fma_f32 v16, -v17, v17, v16
    v_max_f32 v16, 0, v16
    v_add_f32 v16, 0x3727c5ac, v16
    v_rsq_f32 v16, v16
    v_fma_f32 v192, -v17, v193, v192
    v_mul_f32 v192, v16, v192
    v_fma_f32 v196, -v17, v197, v196
    v_mul_f32 v196, v16, v196
    v_fma_f32 v200, -v17, v201, v200
    v_mul_f32 v200, v16, v200
    v_fma_f32 v204, -v17, v205, v204
    v_mul_f32 v204, v16, v204
    v_fma_f32 v208, -v17, v209, v208
    v_mul_f32 v208, v16, v208
    v_fma_f32 v212, -v17, v213, v212
    v_mul_f32 v212, v16, v212
    v_fma_f32 v216, -v17, v217, v216
    v_mul_f32 v216, v16, v216
    v_fma_f32 v220, -v17, v221, v220
    v_mul_f32 v220, v16, v220
    v_add_u32 v16, 1024, v10
    s_mov_b64 exec, s[4:5]
    ds_write2_b32 v16, v192, v193 offset0:0 offset1:128
    ds_write2_b32 v16, v196, v197 offset0:16 offset1:144
    ds_write2_b32 v16, v200, v201 offset0:32 offset1:160
    ds_write2_b32 v16, v204, v205 offset0:48 offset1:176
    ds_write2_b32 v16, v208, v209 offset0:64 offset1:192
    ds_write2_b32 v16, v212, v213 offset0:80 offset1:208
    ds_write2_b32 v16, v216, v217 offset0:96 offset1:224
    ds_write2_b32 v16, v220, v221 offset0:112 offset1:240
    s_mov_b64 exec, -1
    v_lshlrev_b32 v17, 3, v1
    ds_read_b64 v[24:25], v17 offset:1024
    ds_read_b128 v[12:15], v5 offset:1024
    v_readfirstlane_b32 s28, v248
    v_readfirstlane_b32 s96, v249
    s_getreg_b32 s95, hwreg(HW_REG_XCC_ID, 0, 4)
    s_add_u32 s28, s28, 1
    s_and_b32 s96, s96, 0xffffff00
    s_or_b32 s95, s95, s96
    v_mov_b32 v29, s28
    v_mov_b32 v31, s28
    s_lshl_b32 s22, s82, 10
    s_add_u32 s22, s22, 1048576
    s_waitcnt lgkmcnt(0)
    v_mov_b32 v28, v24
    v_mov_b32 v30, v25
    buffer_store_dwordx4 v[28:31], v5, s[56:59], s22 offen
    v_and_or_b32 v12, v12, -4, s98
    v_and_or_b32 v13, v13, -4, s98
    v_and_or_b32 v14, v14, -4, s98
    v_and_or_b32 v15, v15, -4, s98
    v_lshrrev_b32 v27, 5, v1
    v_lshlrev_b32 v27, 17, v27
    v_and_b32 v17, 31, v1
    v_lshl_add_u32 v27, v17, 4, v27
    s_lshl_b32 s23, s82, 9
    v_add_u32 v16, 224, v1
    s_lshl_b32 s93, s80, 5
    v_add_u32 v17, s93, v1
    v_cmp_gt_u32 vcc, 32, v1
    s_nop 1
    v_cndmask_b32 v26, v16, v17, vcc
    v_lshlrev_b32 v26, 7, v26
    s_mov_b32 s94, 524288
    s_lshl_b32 s93, s83, 13
    s_add_u32 s93, s93, 1048576
    s_add_u32 s96, s93, 4096
    s_cmp_lt_u32 s81, 22
    s_cbranch_scc1 NCL_5
    v_mov_b32 v224, -1
    v_mov_b32 v225, -1
    v_mov_b32 v226, -1
    v_mov_b32 v227, -1
    s_mul_i32 s99, s80, 10
    s_add_u32 s99, s99, s81
    s_mul_i32 s99, s99, 3072
    s_add_u32 s99, s99, 522240
    buffer_store_dwordx4 v[224:227], v5, s[56:59], s99 offen offset:0 sc1
    buffer_store_dwordx4 v[224:227], v5, s[56:59], s99 offen offset:1024 sc1
    buffer_store_dwordx4 v[224:227], v5, s[56:59], s99 offen offset:2048 sc1
NCL_5:
    v_lshlrev_b32 v16, 10, v1
    s_sub_u32 s99, s81, 22
    s_lshl_b32 s101, s80, 3
    s_add_u32 s101, s101, s99
    s_lshl_b32 s101, s101, 16
    s_cmp_lt_u32 s99, 8
    s_cselect_b32 s101, s101, 268435456
    buffer_load_dword v240, v16, s[44:47], s101 offen offset:384
    v_mov_b32 v17, 0
TRIG_6:
    s_sleep 2
    ds_read_b32 v18, v17 offset:272
    s_waitcnt lgkmcnt(0)
    v_cmp_gt_u32 vcc, 1, v18
    s_nop 0
    s_cbranch_vccnz TRIG_6
    s_and_b32 s99, s82, 191
    s_lshl_b32 s99, s99, 7
    s_mov_b32 s36, -1
    s_mov_b32 s37, -1
    s_xor_b32 s101, s99, 528384
    s_memtime s[38:39]
    s_waitcnt lgkmcnt(0)
    s_load_dword s1, s[56:57], s101
    s_waitcnt lgkmcnt(0)
    s_memtime s[0:1]
    s_waitcnt lgkmcnt(0)
    s_sub_u32 s0, s0, s38
    s_min_u32 s36, s36, s0
    s_cmp_lt_u32 s0, 540
    s_cbranch_scc1 PRD_7
    s_xor_b32 s101, s99, 536576
    s_memtime s[38:39]
    s_waitcnt lgkmcnt(0)
    s_load_dword s1, s[56:57], s101
    s_waitcnt lgkmcnt(0)
    s_memtime s[0:1]
    s_waitcnt lgkmcnt(0)
    s_sub_u32 s0, s0, s38
    s_min_u32 s37, s37, s0
    s_cmp_lt_u32 s0, 540
    s_cbranch_scc1 PRD_7
    s_xor_b32 s101, s99, 540672
    s_memtime s[38:39]
    s_waitcnt lgkmcnt(0)
    s_load_dword s1, s[56:57], s101
    s_waitcnt lgkmcnt(0)
    s_memtime s[0:1]
    s_waitcnt lgkmcnt(0)
    s_sub_u32 s0, s0, s38
    s_min_u32 s36, s36, s0
    s_cmp_lt_u32 s0, 540
    s_cbranch_scc1 PRD_7
    s_xor_b32 s101, s99, 548864
    s_memtime s[38:39]
    s_waitcnt lgkmcnt(0)
    s_load_dword s1, s[56:57], s101
    s_waitcnt lgkmcnt(0)
    s_memtime s[0:1]
    s_waitcnt lgkmcnt(0)
    s_sub_u32 s0, s0, s38
    s_min_u32 s37, s37, s0
    s_cmp_lt_u32 s0, 540
    s_cbranch_scc1 PRD_7
    s_xor_b32 s101, s99, 544768
    s_memtime s[38:39]
    s_waitcnt lgkmcnt(0)
    s_load_dword s1, s[56:57], s101
    s_waitcnt lgkmcnt(0)
    s_memtime s[0:1]
    s_waitcnt lgkmcnt(0)
    s_sub_u32 s0, s0, s38
    s_min_u32 s36, s36, s0
    s_cmp_lt_u32 s0, 540
    s_cbranch_scc1 PRD_7
    s_xor_b32 s101, s99, 552960
    s_memtime s[38:39]
    s_waitcnt lgkmcnt(0)
    s_load_dword s1, s[56:57], s101
    s_waitcnt lgkmcnt(0)
    s_memtime s[0:1]
    s_waitcnt lgkmcnt(0)
    s_sub_u32 s0, s0, s38
    s_min_u32 s37, s37, s0
PRD_7:
    s_cmp_lt_u32 s37, s36
    s_cselect_b32 s0, 8192, 0
TRIG_8:
    s_sleep 2
    ds_read_b32 v18, v17 offset:272
    s_waitcnt lgkmcnt(0)
    v_cmp_gt_u32 vcc, 2, v18
    s_nop 0
    s_cbranch_vccnz TRIG_8
    buffer_load_dwordx4 v[192:195], v5, s[56:59], s93 offen offset:0 sc1
    buffer_load_dwordx4 v[196:199], v5, s[56:59], s93 offen offset:1024 sc1
    buffer_load_dwordx4 v[200:203], v5, s[56:59], s93 offen offset:2048 sc1
    buffer_load_dwordx4 v[204:207], v5, s[56:59], s93 offen offset:3072 sc1
    buffer_load_dwordx4 v[208:211], v5, s[56:59], s96 offen offset:0 sc1
    buffer_load_dwordx4 v[212:215], v5, s[56:59], s96 offen offset:1024 sc1
    buffer_load_dwordx4 v[216:219], v5, s[56:59], s96 offen offset:2048 sc1
    buffer_load_dwordx4 v[220:223], v5, s[56:59], s96 offen offset:3072 sc1
    buffer_load_dwordx2 v[20:21], v26, s[56:59], s94 offen sc1
    s_branch FLAG1_10
FLAG_9:
    buffer_load_dwordx2 v[20:21], v26, s[56:59], s94 offen sc1
FLAG1_10:
    s_waitcnt vmcnt(0)
    v_xor_b32 v20, s28, v20
    v_xor_b32 v21, s95, v21
    v_lshrrev_b32 v17, 8, v21
    v_or_b32 v16, v20, v17
    v_cmp_ne_u32 vcc, 0, v16
    s_nop 0
    s_cbranch_vccz FLAGD_11
    s_sleep 8
    s_add_u32 s90, s90, 8
    s_cmp_lt_u32 s90, 400000
    s_cbranch_scc1 FLAG_9
FLAGD_11:
    v_cmp_ne_u32 vcc, 0, v21
    s_nop 0
    s_cmp_eq_u32 vcc_lo, 0
    s_cselect_b32 s89, 1, 0
    s_or_b32 s89, s89, s0
    v_mov_b32 v16, s89
    v_mov_b32 v17, 256
    ds_write_b32 v17, v16
    s_and_b32 s0, s89, 8192
    s_and_b32 s89, s89, 1
    s_cmp_lg_u32 s89, 0
    s_cselect_b32 s78, 0x10000000, 0
    s_cselect_b32 s34, 0, 0x10000000
    buffer_store_dwordx4 v[12:15], v27, s[76:79], s23 offen
    buffer_store_dwordx4 v[12:15], v27, s[32:35], s23 offen sc1
    buffer_store_dwordx4 v[28:31], v5, s[32:35], s22 offen sc1
    s_nop 0
    s_branch QG0_13
QG_12:
    buffer_load_dwordx4 v[192:195], v5, s[56:59], s93 offen offset:0 sc1
    buffer_load_dwordx4 v[196:199], v5, s[56:59], s93 offen offset:1024 sc1
    buffer_load_dwordx4 v[200:203], v5, s[56:59], s93 offen offset:2048 sc1
    buffer_load_dwordx4 v[204:207], v5, s[56:59], s93 offen offset:3072 sc1
    buffer_load_dwordx4 v[208:211], v5, s[56:59], s96 offen offset:0 sc1
    buffer_load_dwordx4 v[212:215], v5, s[56:59], s96 offen offset:1024 sc1
    buffer_load_dwordx4 v[216:219], v5, s[56:59], s96 offen offset:2048 sc1
    buffer_load_dwordx4 v[220:223], v5, s[56:59], s96 offen offset:3072 sc1
    s_waitcnt vmcnt(0)
QG0_13:
    v_mov_b32 v16, 0
    v_xor_b32 v193, s28, v193
    v_xor_b32 v195, s28, v195
    v_or3_b32 v16, v16, v193, v195
    v_xor_b32 v197, s28, v197
    v_xor_b32 v199, s28, v199
    v_or3_b32 v16, v16, v197, v199
    v_xor_b32 v201, s28, v201
    v_xor_b32 v203, s28, v203
    v_or3_b32 v16, v16, v201, v203
    v_xor_b32 v205, s28, v205
    v_xor_b32 v207, s28, v207
    v_or3_b32 v16, v16, v205, v207
    v_xor_b32 v209, s28, v209
    v_xor_b32 v211, s28, v211
    v_or3_b32 v16, v16, v209, v211
    v_xor_b32 v213, s28, v213
    v_xor_b32 v215, s28, v215
    v_or3_b32 v16, v16, v213, v215
    v_xor_b32 v217, s28, v217
    v_xor_b32 v219, s28, v219
    v_or3_b32 v16, v16, v217, v219
    v_xor_b32 v221, s28, v221
    v_xor_b32 v223, s28, v223
    v_or3_b32 v16, v16, v221, v223
    v_cmp_ne_u32 vcc, 0, v16
    s_nop 0
    s_cbranch_vccz QGD_14
    s_sleep 8
    s_add_u32 s90, s90, 8
    s_cmp_lt_u32 s90, 400000
    s_cbranch_scc1 QG_12
QGD_14:
    v_add_f32 v20, v192, v196
    v_add_f32 v21, v194, v198
    v_add_f32 v20, v20, v200
    v_add_f32 v21, v21, v202
    v_add_f32 v20, v20, v204
    v_add_f32 v21, v21, v206
    v_add_f32 v20, v20, v208
    v_add_f32 v21, v21, v210
    v_add_f32 v20, v20, v212
    v_add_f32 v21, v21, v214
    v_add_f32 v20, v20, v216
    v_add_f32 v21, v21, v218
    v_add_f32 v20, v20, v220
    v_add_f32 v21, v21, v222
    v_cvt_pk_bf16_f32 v20, v20, v21
    v_bfe_u32 v16, v1, 4, 1
    v_lshlrev_b32 v16, 7, v16
    v_and_b32 v17, 1, v1
    v_lshl_add_u32 v16, v17, 6, v16
    v_lshrrev_b32 v17, 5, v1
    v_lshl_add_u32 v16, v17, 5, v16
    v_bfe_u32 v17, v1, 1, 3
    v_lshl_add_u32 v16, v17, 2, v16
    ds_write_b32 v16, v20 offset:0
    v_mov_b32 v224, 0
    v_mov_b32 v225, 0
    v_mov_b32 v226, 0
    v_mov_b32 v227, 0
    v_mov_b32 v228, 0
    v_mov_b32 v229, 0
    v_mov_b32 v230, 0
    v_mov_b32 v231, 0
    v_mov_b32 v232, 0
    v_mov_b32 v234, 0
    v_mov_b32 v236, 0
    v_mov_b32 v238, 0
    v_mov_b32 v192, 0
    v_mov_b32 v193, 0
    v_mov_b32 v194, 0
    v_mov_b32 v195, 0
    v_mov_b32 v196, 0
    v_mov_b32 v197, 0
    v_mov_b32 v198, 0
    v_mov_b32 v199, 0
    v_mov_b32 v200, 0
    v_mov_b32 v201, 0
    v_mov_b32 v202, 0
    v_mov_b32 v203, 0
    v_mov_b32 v204, 0
    v_mov_b32 v205, 0
    v_mov_b32 v206, 0
    v_mov_b32 v207, 0
    v_and_b32 v16, 1, v2
    v_lshlrev_b32 v16, 7, v16
    v_bfe_u32 v17, v2, 1, 1
    v_lshl_add_u32 v16, v17, 6, v16
    v_lshl_add_u32 v16, v3, 4, v16
    v_lshrrev_b32 v17, 2, v2
    v_mov_b32 v18, 288
    v_cmp_eq_u32 vcc, 0, v17
    s_nop 1
    v_cndmask_b32 v12, v18, v16, vcc
    v_cmp_eq_u32 vcc, 1, v17
    s_nop 1
    v_cndmask_b32 v13, v18, v16, vcc
    v_cmp_eq_u32 vcc, 2, v17
    s_nop 1
    v_cndmask_b32 v14, v18, v16, vcc
    v_cmp_eq_u32 vcc, 3, v17
    s_nop 1
    v_cndmask_b32 v15, v18, v16, vcc
    s_lshl_b32 s93, s85, 9
    v_lshl_add_u32 v31, v2, 5, s93
    v_lshl_add_u32 v31, v3, 3, v31
    s_lshl_b32 s93, s85, 8
    v_add_u32 v29, s93, v10
    v_lshlrev_b32 v27, 3, v1
    v_and_b32 v28, 7, v1
    v_lshlrev_b32 v28, 8, v28
    v_and_b32 v16, 12, v10
    v_lshrrev_b32 v17, 2, v1
    v_lshl_add_u32 v30, v17, 8, v16
    s_nop 0
    s_branch L_S2W0
L_S2W0:
    ds_read_b128 v[208:211], v12 offset:0
    ds_read_b128 v[212:215], v13 offset:0
    ds_read_b128 v[216:219], v14 offset:0
    ds_read_b128 v[220:223], v15 offset:0
    s_waitcnt lgkmcnt(3)
    v_smfmac_f32_16x16x64_bf16 v[224:227], v[208:211], v[32:39], v4
    v_smfmac_f32_16x16x64_bf16 v[228:231], v[208:211], v[64:71], v4
    s_waitcnt lgkmcnt(2)
    v_smfmac_f32_16x16x64_bf16 v[224:227], v[212:215], v[40:47], v4
    v_smfmac_f32_16x16x64_bf16 v[228:231], v[212:215], v[72:79], v4
    s_waitcnt lgkmcnt(1)
    v_smfmac_f32_16x16x64_bf16 v[224:227], v[216:219], v[48:55], v4
    v_smfmac_f32_16x16x64_bf16 v[228:231], v[216:219], v[80:87], v4
    s_waitcnt lgkmcnt(0)
    v_smfmac_f32_16x16x64_bf16 v[224:227], v[220:223], v[56:63], v4
    v_smfmac_f32_16x16x64_bf16 v[228:231], v[220:223], v[88:95], v4
    s_nop 6
    v_pk_add_f32 v[24:25], v[224:225], v[226:227]
    v_pk_add_f32 v[22:23], v[228:229], v[230:231]
    v_cndmask_b32_e64 v25, v22, v25, s[20:21]
    v_cndmask_b32_e64 v24, v24, v23, s[20:21]
    s_nop 1
    v_add_f32_dpp v25, v25, v24 row_ror:8 row_mask:0xf bank_mask:0xf
    v_mul_f32 v24, s30, v25
    s_nop 0
    v_max_f32_dpp v25, v25, v25 quad_perm:[1,0,3,2] row_mask:0xf bank_mask:0xf
    s_nop 1
    v_max_f32_dpp v25, v25, v25 quad_perm:[2,3,0,1] row_mask:0xf bank_mask:0xf
    s_nop 1
    v_max_f32_dpp v25, v25, v25 row_half_mirror row_mask:0xf bank_mask:0xf
    s_nop 1
    v_max_f32_dpp v25, v25, v25 row_mirror row_mask:0xf bank_mask:0xf
    v_mov_b32 v26, v25
    s_nop 1
    v_permlane16_swap_b32 v25, v26
    v_max_f32 v25, v25, v26
    v_mov_b32 v26, v25
    s_nop 1
    v_permlane32_swap_b32 v25, v26
    v_max_f32 v25, v25, v26
    v_fma_f32 v24, -v25, s30, v24
    v_exp_f32 v24, v24
    v_mul_f32 v25, s30, v25
    s_nop 0
    v_mov_b32_dpp v26, v24 quad_perm:[1,1,3,3] row_mask:0xf bank_mask:0xf
    v_cvt_pk_bf16_f32 v26, v24, v26
    ds_write2st64_b32 v29, v24, v25 offset0:56 offset1:64
    s_nop 0
    v_mov_b32_dpp v192, v26 quad_perm:[0,1,2,3] row_mask:0xf bank_mask:0x1
    v_mov_b32_dpp v193, v26 row_shl:4 row_mask:0xf bank_mask:0x1
    v_mov_b32_dpp v194, v26 row_shl:8 row_mask:0xf bank_mask:0x1
    v_mov_b32_dpp v195, v26 row_shl:12 row_mask:0xf bank_mask:0x1
    v_mov_b32_dpp v196, v26 row_shr:4 row_mask:0xf bank_mask:0x2
    v_mov_b32_dpp v197, v26 quad_perm:[0,1,2,3] row_mask:0xf bank_mask:0x2
    v_mov_b32_dpp v198, v26 row_shl:4 row_mask:0xf bank_mask:0x2
    v_mov_b32_dpp v199, v26 row_shl:8 row_mask:0xf bank_mask:0x2
    v_mov_b32_dpp v200, v26 row_shr:8 row_mask:0xf bank_mask:0x4
    v_mov_b32_dpp v201, v26 row_shr:4 row_mask:0xf bank_mask:0x4
    v_mov_b32_dpp v202, v26 quad_perm:[0,1,2,3] row_mask:0xf bank_mask:0x4
    v_mov_b32_dpp v203, v26 row_shl:4 row_mask:0xf bank_mask:0x4
    v_mov_b32_dpp v204, v26 row_shr:12 row_mask:0xf bank_mask:0x8
    v_mov_b32_dpp v205, v26 row_shr:8 row_mask:0xf bank_mask:0x8
    v_mov_b32_dpp v206, v26 row_shr:4 row_mask:0xf bank_mask:0x8
    v_mov_b32_dpp v207, v26 quad_perm:[0,1,2,3] row_mask:0xf bank_mask:0x8
    s_waitcnt vmcnt(6)
    v_perm_b32 v96, v108, v100, s14
    v_perm_b32 v104, v108, v100, s15
    v_perm_b32 v112, v109, v101, s14
    v_perm_b32 v120, v109, v101, s15
    v_perm_b32 v128, v110, v102, s14
    v_perm_b32 v136, v110, v102, s15
    v_perm_b32 v144, v111, v103, s14
    v_perm_b32 v152, v111, v103, s15
    s_waitcnt vmcnt(4)
    v_perm_b32 v97, v124, v116, s14
    v_perm_b32 v105, v124, v116, s15
    v_perm_b32 v113, v125, v117, s14
    v_perm_b32 v121, v125, v117, s15
    v_perm_b32 v129, v126, v118, s14
    v_perm_b32 v137, v126, v118, s15
    v_perm_b32 v145, v127, v119, s14
    v_perm_b32 v153, v127, v119, s15
    s_waitcnt vmcnt(2)
    v_perm_b32 v98, v140, v132, s14
    v_perm_b32 v106, v140, v132, s15
    v_perm_b32 v114, v141, v133, s14
    v_perm_b32 v122, v141, v133, s15
    v_perm_b32 v130, v142, v134, s14
    v_perm_b32 v138, v142, v134, s15
    v_perm_b32 v146, v143, v135, s14
    v_perm_b32 v154, v143, v135, s15
    s_waitcnt vmcnt(0)
    v_perm_b32 v99, v156, v148, s14
    v_perm_b32 v107, v156, v148, s15
    v_perm_b32 v115, v157, v149, s14
    v_perm_b32 v123, v157, v149, s15
    v_perm_b32 v131, v158, v150, s14
    v_perm_b32 v139, v158, v150, s15
    v_perm_b32 v147, v159, v151, s14
    v_perm_b32 v155, v159, v151, s15
    s_waitcnt vmcnt(6)
    v_perm_b32 v100, v164, v160, s14
    v_perm_b32 v108, v164, v160, s15
    v_perm_b32 v116, v165, v161, s14
    v_perm_b32 v124, v165, v161, s15
    v_perm_b32 v132, v166, v162, s14
    v_perm_b32 v140, v166, v162, s15
    v_perm_b32 v148, v167, v163, s14
    v_perm_b32 v156, v167, v163, s15
    s_waitcnt vmcnt(4)
    v_perm_b32 v101, v172, v168, s14
    v_perm_b32 v109, v172, v168, s15
    v_perm_b32 v117, v173, v169, s14
    v_perm_b32 v125, v173, v169, s15
    v_perm_b32 v133, v174, v170, s14
    v_perm_b32 v141, v174, v170, s15
    v_perm_b32 v149, v175, v171, s14
    v_perm_b32 v157, v175, v171, s15
    s_waitcnt vmcnt(2)
    v_perm_b32 v102, v180, v176, s14
    v_perm_b32 v110, v180, v176, s15
    v_perm_b32 v118, v181, v177, s14
    v_perm_b32 v126, v181, v177, s15
    v_perm_b32 v134, v182, v178, s14
    v_perm_b32 v142, v182, v178, s15
    v_perm_b32 v150, v183, v179, s14
    v_perm_b32 v158, v183, v179, s15
    s_waitcnt vmcnt(0)
    v_perm_b32 v103, v188, v184, s14
    v_perm_b32 v111, v188, v184, s15
    v_perm_b32 v119, v189, v185, s14
    v_perm_b32 v127, v189, v185, s15
    v_smfmac_f32_16x16x64_bf16 v[232:235], v[192:195], v[96:103], v4
    v_smfmac_f32_16x16x64_bf16 v[236:239], v[192:195], v[104:111], v4
    v_perm_b32 v135, v190, v186, s14
    v_perm_b32 v143, v190, v186, s15
    v_smfmac_f32_16x16x64_bf16 v[232:235], v[196:199], v[112:119], v4
    v_smfmac_f32_16x16x64_bf16 v[236:239], v[196:199], v[120:127], v4
    v_perm_b32 v151, v191, v187, s14
    v_perm_b32 v159, v191, v187, s15
    v_smfmac_f32_16x16x64_bf16 v[232:235], v[200:203], v[128:135], v4
    v_smfmac_f32_16x16x64_bf16 v[236:239], v[200:203], v[136:143], v4
    v_smfmac_f32_16x16x64_bf16 v[232:235], v[204:207], v[144:151], v4
    v_smfmac_f32_16x16x64_bf16 v[236:239], v[204:207], v[152:159], v4
    s_waitcnt lgkmcnt(0)
    s_barrier
    s_mov_b32 s101, 0
MW_15:
    ds_read_b32 v23, v28 offset:16384
    s_add_u32 s101, s101, 1
    s_cmp_lt_u32 s101, 100000
    s_cselect_b32 s99, s25, 0x7fc00000
    s_waitcnt lgkmcnt(0)
    v_max_f32_dpp v22, v23, v23 quad_perm:[1,0,3,2] row_mask:0xf bank_mask:0xf
    s_nop 1
    v_max_f32_dpp v22, v22, v22 quad_perm:[2,3,0,1] row_mask:0xf bank_mask:0xf
    s_nop 1
    v_max_f32_dpp v22, v22, v22 row_half_mirror row_mask:0xf bank_mask:0xf
    v_cmp_eq_f32 vcc, s99, v22
    s_cbranch_vccnz MW_15
    v_sub_f32 v20, v25, v22
    v_exp_f32 v20, v20
    v_add_f32 v18, v232, v234
    v_add_f32 v19, v236, v238
    v_pk_mul_f32 v[18:19], v[18:19], v[20:21] op_sel:[0,0] op_sel_hi:[1,0]
    ds_write_b64 v31, v[18:19] offset:1024
    s_cmp_eq_u32 s31, 0
    s_cbranch_scc1 WE_16
    s_barrier
    s_cmp_eq_u32 s87, 1
    s_cselect_b32 s48, s44, s48
    s_cselect_b32 s49, s45, s49
    s_cselect_b32 s50, s46, s50
    s_movk_i32 s37, 2752
    s_cselect_b32 s37, 1024, s37
    s_cselect_b32 s94, s81, s86
    s_cselect_b32 s22, s80, 0
    v_lshrrev_b32 v16, 2, v1
    v_and_b32 v17, 48, v5
    v_mad_u32_u24 v17, v16, s37, v17
    s_lshl_b32 s22, s22, 19
    s_lshl_b32 s94, s94, 6
    s_add_u32 s36, s94, s22
    s_lshl_b32 s37, s37, 4
    s_lshl_b32 s93, s85, 2
    s_mul_i32 s93, s93, s37
    s_add_u32 s36, s36, s93
    s_lshl_b32 s95, s85, 12
    s_add_u32 m0, s95, 36864
    s_nop 0
    buffer_load_dwordx4 v17, s[48:51], s36 offen lds
    s_add_u32 s36, s36, s37
    s_add_u32 m0, m0, 1024
    s_nop 0
    buffer_load_dwordx4 v17, s[48:51], s36 offen lds
    s_add_u32 s36, s36, s37
    s_add_u32 m0, m0, 1024
    s_nop 0
    buffer_load_dwordx4 v17, s[48:51], s36 offen lds
    s_add_u32 s36, s36, s37
    s_add_u32 m0, m0, 1024
    s_nop 0
    buffer_load_dwordx4 v17, s[48:51], s36 offen lds
    s_branch L_B2
WE_16:
    s_waitcnt vmcnt(0)
    s_branch L_B2
L_QBAR:
    v_mov_b32 v16, 256
    s_waitcnt lgkmcnt(0)
    s_barrier
    ds_read_b32 v16, v16
    s_waitcnt lgkmcnt(0)
    v_readfirstlane_b32 s89, v16
    s_nop 0
    s_and_b32 s0, s89, 8192
    s_and_b32 s89, s89, 1
    s_cmp_lg_u32 s89, 0
    s_cselect_b32 s78, 0x10000000, 0
    s_cselect_b32 s34, 0, 0x10000000
    ds_read_b128 v[208:211], v12 offset:0
    ds_read_b128 v[212:215], v13 offset:0
    ds_read_b128 v[216:219], v14 offset:0
    ds_read_b128 v[220:223], v15 offset:0
    s_waitcnt vmcnt(12)
    s_waitcnt lgkmcnt(3)
    v_smfmac_f32_16x16x64_bf16 v[224:227], v[208:211], v[32:39], v4
    v_smfmac_f32_16x16x64_bf16 v[228:231], v[208:211], v[64:71], v4
    s_waitcnt lgkmcnt(2)
    v_smfmac_f32_16x16x64_bf16 v[224:227], v[212:215], v[40:47], v4
    v_smfmac_f32_16x16x64_bf16 v[228:231], v[212:215], v[72:79], v4
    s_waitcnt lgkmcnt(1)
    v_smfmac_f32_16x16x64_bf16 v[224:227], v[216:219], v[48:55], v4
    v_smfmac_f32_16x16x64_bf16 v[228:231], v[216:219], v[80:87], v4
    s_waitcnt lgkmcnt(0)
    v_smfmac_f32_16x16x64_bf16 v[224:227], v[220:223], v[56:63], v4
    v_smfmac_f32_16x16x64_bf16 v[228:231], v[220:223], v[88:95], v4
    s_nop 6
    v_pk_add_f32 v[24:25], v[224:225], v[226:227]
    v_pk_add_f32 v[22:23], v[228:229], v[230:231]
    v_cndmask_b32_e64 v25, v22, v25, s[20:21]
    v_cndmask_b32_e64 v24, v24, v23, s[20:21]
    s_nop 1
    v_add_f32_dpp v25, v25, v24 row_ror:8 row_mask:0xf bank_mask:0xf
    v_mul_f32 v24, s30, v25
    s_nop 0
    v_max_f32_dpp v25, v25, v25 quad_perm:[1,0,3,2] row_mask:0xf bank_mask:0xf
    s_nop 1
    v_max_f32_dpp v25, v25, v25 quad_perm:[2,3,0,1] row_mask:0xf bank_mask:0xf
    s_nop 1
    v_max_f32_dpp v25, v25, v25 row_half_mirror row_mask:0xf bank_mask:0xf
    s_nop 1
    v_max_f32_dpp v25, v25, v25 row_mirror row_mask:0xf bank_mask:0xf
    v_mov_b32 v26, v25
    s_nop 1
    v_permlane16_swap_b32 v25, v26
    v_max_f32 v25, v25, v26
    v_mov_b32 v26, v25
    s_nop 1
    v_permlane32_swap_b32 v25, v26
    v_max_f32 v25, v25, v26
    v_fma_f32 v24, -v25, s30, v24
    v_exp_f32 v24, v24
    v_mul_f32 v25, s30, v25
    s_nop 0
    v_mov_b32_dpp v26, v24 quad_perm:[1,1,3,3] row_mask:0xf bank_mask:0xf
    v_cvt_pk_bf16_f32 v26, v24, v26
    ds_write2st64_b32 v29, v24, v25 offset0:56 offset1:64
    s_add_u32 s93, s91, 98304
    buffer_load_dwordx4 v[176:179], v5, s[36:39], s93 offen offset:0 nt
    s_add_u32 s93, s91, 98304
    buffer_load_dwordx4 v[180:183], v5, s[36:39], s93 offen offset:1024 nt
    s_add_u32 s93, s91, 98304
    buffer_load_dwordx4 v[184:187], v5, s[36:39], s93 offen offset:2048 nt
    s_add_u32 s93, s91, 98304
    buffer_load_dwordx4 v[188:191], v5, s[36:39], s93 offen offset:3072 nt
    v_mov_b32_dpp v192, v26 quad_perm:[0,1,2,3] row_mask:0xf bank_mask:0x1
    v_mov_b32_dpp v193, v26 row_shl:4 row_mask:0xf bank_mask:0x1
    v_mov_b32_dpp v194, v26 row_shl:8 row_mask:0xf bank_mask:0x1
    v_mov_b32_dpp v195, v26 row_shl:12 row_mask:0xf bank_mask:0x1
    v_mov_b32_dpp v196, v26 row_shr:4 row_mask:0xf bank_mask:0x2
    v_mov_b32_dpp v197, v26 quad_perm:[0,1,2,3] row_mask:0xf bank_mask:0x2
    v_mov_b32_dpp v198, v26 row_shl:4 row_mask:0xf bank_mask:0x2
    v_mov_b32_dpp v199, v26 row_shl:8 row_mask:0xf bank_mask:0x2
    v_mov_b32_dpp v200, v26 row_shr:8 row_mask:0xf bank_mask:0x4
    v_mov_b32_dpp v201, v26 row_shr:4 row_mask:0xf bank_mask:0x4
    v_mov_b32_dpp v202, v26 quad_perm:[0,1,2,3] row_mask:0xf bank_mask:0x4
    v_mov_b32_dpp v203, v26 row_shl:4 row_mask:0xf bank_mask:0x4
    v_mov_b32_dpp v204, v26 row_shr:12 row_mask:0xf bank_mask:0x8
    v_mov_b32_dpp v205, v26 row_shr:8 row_mask:0xf bank_mask:0x8
    v_mov_b32_dpp v206, v26 row_shr:4 row_mask:0xf bank_mask:0x8
    v_mov_b32_dpp v207, v26 quad_perm:[0,1,2,3] row_mask:0xf bank_mask:0x8
    s_mov_b32 s101, 0
MW_17:
    ds_read_b32 v23, v28 offset:16384
    s_add_u32 s101, s101, 1
    s_cmp_lt_u32 s101, 100000
    s_cselect_b32 s99, s25, 0x7fc00000
    s_waitcnt lgkmcnt(0)
    v_max_f32_dpp v22, v23, v23 quad_perm:[1,0,3,2] row_mask:0xf bank_mask:0xf
    s_nop 1
    v_max_f32_dpp v22, v22, v22 quad_perm:[2,3,0,1] row_mask:0xf bank_mask:0xf
    s_nop 1
    v_max_f32_dpp v22, v22, v22 row_half_mirror row_mask:0xf bank_mask:0xf
    v_cmp_eq_f32 vcc, s99, v22
    s_cbranch_vccnz MW_17
    v_sub_f32 v20, v25, v22
    v_exp_f32 v20, v20
    s_cmp_lg_u32 s85, 1
    s_cbranch_scc1 W0_18
    v_lshlrev_b32 v16, 1, v5
    v_and_b32 v17, 0x700, v16
    ds_read_b32 v23, v17 offset:16384
    ds_read_b128 v[208:211], v16 offset:14336
    ds_read_b128 v[212:215], v16 offset:14352
    s_waitcnt lgkmcnt(2)
    v_sub_f32 v23, v23, v22
    v_exp_f32 v23, v23
    s_waitcnt lgkmcnt(0)
    v_pk_add_f32 v[208:209], v[208:209], v[210:211]
    v_pk_add_f32 v[212:213], v[212:213], v[214:215]
    v_pk_add_f32 v[208:209], v[208:209], v[212:213]
    v_add_f32 v16, v208, v209
    v_mul_f32 v23, v23, v16
W0_18:
    s_waitcnt vmcnt(14)
    v_perm_b32 v96, v108, v100, s14
    v_perm_b32 v104, v108, v100, s15
    v_perm_b32 v112, v109, v101, s14
    v_perm_b32 v120, v109, v101, s15
    v_perm_b32 v128, v110, v102, s14
    v_perm_b32 v136, v110, v102, s15
    v_perm_b32 v144, v111, v103, s14
    v_perm_b32 v152, v111, v103, s15
    s_waitcnt vmcnt(12)
    v_perm_b32 v97, v124, v116, s14
    v_perm_b32 v105, v124, v116, s15
    v_perm_b32 v113, v125, v117, s14
    v_perm_b32 v121, v125, v117, s15
    v_perm_b32 v129, v126, v118, s14
    v_perm_b32 v137, v126, v118, s15
    v_perm_b32 v145, v127, v119, s14
    v_perm_b32 v153, v127, v119, s15
    s_waitcnt vmcnt(10)
    v_perm_b32 v98, v140, v132, s14
    v_perm_b32 v106, v140, v132, s15
    v_perm_b32 v114, v141, v133, s14
    v_perm_b32 v122, v141, v133, s15
    v_perm_b32 v130, v142, v134, s14
    v_perm_b32 v138, v142, v134, s15
    v_perm_b32 v146, v143, v135, s14
    v_perm_b32 v154, v143, v135, s15
    s_waitcnt vmcnt(8)
    v_perm_b32 v99, v156, v148, s14
    v_perm_b32 v107, v156, v148, s15
    v_perm_b32 v115, v157, v149, s14
    v_perm_b32 v123, v157, v149, s15
    v_perm_b32 v131, v158, v150, s14
    v_perm_b32 v139, v158, v150, s15
    v_perm_b32 v147, v159, v151, s14
    v_perm_b32 v155, v159, v151, s15
    s_cmp_eq_u32 s31, 0
    s_cbranch_scc1 NR_19
    s_barrier
    s_cmp_eq_u32 s87, 1
    s_cselect_b32 s48, s44, s48
    s_cselect_b32 s49, s45, s49
    s_cselect_b32 s50, s46, s50
    s_movk_i32 s37, 2752
    s_cselect_b32 s37, 1024, s37
    s_cselect_b32 s94, s81, s86
    s_cselect_b32 s22, s80, 0
    v_lshrrev_b32 v16, 2, v1
    v_and_b32 v17, 48, v5
    v_mad_u32_u24 v17, v16, s37, v17
    s_lshl_b32 s22, s22, 19
    s_lshl_b32 s94, s94, 6
    s_add_u32 s36, s94, s22
    s_lshl_b32 s37, s37, 4
    s_lshl_b32 s93, s85, 2
    s_mul_i32 s93, s93, s37
    s_add_u32 s36, s36, s93
    s_lshl_b32 s95, s85, 12
    s_add_u32 m0, s95, 36864
    s_nop 0
    buffer_load_dwordx4 v17, s[48:51], s36 offen lds
    s_add_u32 s36, s36, s37
    s_add_u32 m0, m0, 1024
    s_nop 0
    buffer_load_dwordx4 v17, s[48:51], s36 offen lds
    s_add_u32 s36, s36, s37
    s_add_u32 m0, m0, 1024
    s_nop 0
    buffer_load_dwordx4 v17, s[48:51], s36 offen lds
    s_add_u32 s36, s36, s37
    s_add_u32 m0, m0, 1024
    s_nop 0
    buffer_load_dwordx4 v17, s[48:51], s36 offen lds
    s_waitcnt vmcnt(10)
    v_perm_b32 v100, v164, v160, s14
    v_perm_b32 v108, v164, v160, s15
    v_perm_b32 v116, v165, v161, s14
    v_perm_b32 v124, v165, v161, s15
    v_perm_b32 v132, v166, v162, s14
    v_perm_b32 v140, v166, v162, s15
    v_perm_b32 v148, v167, v163, s14
    v_perm_b32 v156, v167, v163, s15
    s_waitcnt vmcnt(8)
    v_perm_b32 v101, v172, v168, s14
    v_perm_b32 v109, v172, v168, s15
    v_perm_b32 v117, v173, v169, s14
    v_perm_b32 v125, v173, v169, s15
    v_perm_b32 v133, v174, v170, s14
    v_perm_b32 v141, v174, v170, s15
    v_perm_b32 v149, v175, v171, s14
    v_perm_b32 v157, v175, v171, s15
    s_waitcnt vmcnt(6)
    v_perm_b32 v102, v180, v176, s14
    v_perm_b32 v110, v180, v176, s15
    v_perm_b32 v118, v181, v177, s14
    v_perm_b32 v126, v181, v177, s15
    v_perm_b32 v134, v182, v178, s14
    v_perm_b32 v142, v182, v178, s15
    v_perm_b32 v150, v183, v179, s14
    v_perm_b32 v158, v183, v179, s15
    s_waitcnt vmcnt(4)
    v_perm_b32 v103, v188, v184, s14
    v_perm_b32 v111, v188, v184, s15
    v_perm_b32 v119, v189, v185, s14
    v_perm_b32 v127, v189, v185, s15
    v_smfmac_f32_16x16x64_bf16 v[232:235], v[192:195], v[96:103], v4
    v_smfmac_f32_16x16x64_bf16 v[236:239], v[192:195], v[104:111], v4
    v_perm_b32 v135, v190, v186, s14
    v_perm_b32 v143, v190, v186, s15
    v_smfmac_f32_16x16x64_bf16 v[232:235], v[196:199], v[112:119], v4
    v_smfmac_f32_16x16x64_bf16 v[236:239], v[196:199], v[120:127], v4
    v_perm_b32 v151, v191, v187, s14
    v_perm_b32 v159, v191, v187, s15
    v_smfmac_f32_16x16x64_bf16 v[232:235], v[200:203], v[128:135], v4
    v_smfmac_f32_16x16x64_bf16 v[236:239], v[200:203], v[136:143], v4
    v_smfmac_f32_16x16x64_bf16 v[232:235], v[204:207], v[144:151], v4
    v_smfmac_f32_16x16x64_bf16 v[236:239], v[204:207], v[152:159], v4
    s_nop 6
    v_add_f32 v18, v232, v234
    v_add_f32 v19, v236, v238
    v_pk_mul_f32 v[18:19], v[18:19], v[20:21] op_sel:[0,0] op_sel_hi:[1,0]
    ds_write_b64 v31, v[18:19] offset:1024
    s_branch L_B2
NR_19:
    s_waitcnt vmcnt(6)
    v_perm_b32 v100, v164, v160, s14
    v_perm_b32 v108, v164, v160, s15
    v_perm_b32 v116, v165, v161, s14
    v_perm_b32 v124, v165, v161, s15
    v_perm_b32 v132, v166, v162, s14
    v_perm_b32 v140, v166, v162, s15
    v_perm_b32 v148, v167, v163, s14
    v_perm_b32 v156, v167, v163, s15
    s_waitcnt vmcnt(4)
    v_perm_b32 v101, v172, v168, s14
    v_perm_b32 v109, v172, v168, s15
    v_perm_b32 v117, v173, v169, s14
    v_perm_b32 v125, v173, v169, s15
    v_perm_b32 v133, v174, v170, s14
    v_perm_b32 v141, v174, v170, s15
    v_perm_b32 v149, v175, v171, s14
    v_perm_b32 v157, v175, v171, s15
    s_waitcnt vmcnt(2)
    v_perm_b32 v102, v180, v176, s14
    v_perm_b32 v110, v180, v176, s15
    v_perm_b32 v118, v181, v177, s14
    v_perm_b32 v126, v181, v177, s15
    v_perm_b32 v134, v182, v178, s14
    v_perm_b32 v142, v182, v178, s15
    v_perm_b32 v150, v183, v179, s14
    v_perm_b32 v158, v183, v179, s15
    s_waitcnt vmcnt(0)
    v_perm_b32 v103, v188, v184, s14
    v_perm_b32 v111, v188, v184, s15
    v_perm_b32 v119, v189, v185, s14
    v_perm_b32 v127, v189, v185, s15
    v_smfmac_f32_16x16x64_bf16 v[232:235], v[192:195], v[96:103], v4
    v_smfmac_f32_16x16x64_bf16 v[236:239], v[192:195], v[104:111], v4
    v_perm_b32 v135, v190, v186, s14
    v_perm_b32 v143, v190, v186, s15
    v_smfmac_f32_16x16x64_bf16 v[232:235], v[196:199], v[112:119], v4
    v_smfmac_f32_16x16x64_bf16 v[236:239], v[196:199], v[120:127], v4
    v_perm_b32 v151, v191, v187, s14
    v_perm_b32 v159, v191, v187, s15
    v_smfmac_f32_16x16x64_bf16 v[232:235], v[200:203], v[128:135], v4
    v_smfmac_f32_16x16x64_bf16 v[236:239], v[200:203], v[136:143], v4
    v_smfmac_f32_16x16x64_bf16 v[232:235], v[204:207], v[144:151], v4
    v_smfmac_f32_16x16x64_bf16 v[236:239], v[204:207], v[152:159], v4
    s_nop 6
    v_add_f32 v18, v232, v234
    v_add_f32 v19, v236, v238
    v_pk_mul_f32 v[18:19], v[18:19], v[20:21] op_sel:[0,0] op_sel_hi:[1,0]
    ds_write_b64 v31, v[18:19] offset:1024
L_B2:
    s_cmp_lg_u32 s85, 0
    s_waitcnt lgkmcnt(0)
    s_barrier
    s_cbranch_scc1 L_NW0
    ds_read_b64 v[208:209], v27 offset:1024
    ds_read_b64 v[210:211], v27 offset:1536
    ds_read_b64 v[212:213], v27 offset:2048
    ds_read_b64 v[214:215], v27 offset:2560
    ds_read_b64 v[216:217], v27 offset:3072
    ds_read_b64 v[218:219], v27 offset:3584
    ds_read_b64 v[220:221], v27 offset:4096
    ds_read_b64 v[222:223], v27 offset:4608
    s_waitcnt lgkmcnt(6)
    v_pk_add_f32 v[24:25], v[208:209], v[210:211]
    s_waitcnt lgkmcnt(5)
    v_pk_add_f32 v[24:25], v[24:25], v[212:213]
    s_waitcnt lgkmcnt(4)
    v_pk_add_f32 v[24:25], v[24:25], v[214:215]
    s_waitcnt lgkmcnt(3)
    v_pk_add_f32 v[24:25], v[24:25], v[216:217]
    s_waitcnt lgkmcnt(2)
    v_pk_add_f32 v[24:25], v[24:25], v[218:219]
    s_waitcnt lgkmcnt(1)
    v_pk_add_f32 v[24:25], v[24:25], v[220:221]
    s_waitcnt lgkmcnt(0)
    v_pk_add_f32 v[24:25], v[24:25], v[222:223]
    v_cvt_pk_bf16_f32 v26, v24, v25
    v_and_or_b32 v26, v26, -4, s98
    buffer_store_dword v26, v30, s[76:79], s12 offen
    v_lshlrev_b32 v22, 16, v26
    v_and_b32 v23, 0xffff0000, v26
    v_pk_add_f32 v[24:25], v[24:25], v[22:23] neg_lo:[0,1] neg_hi:[0,1]
    v_cvt_pk_bf16_f32 v21, v24, v25
    v_and_or_b32 v21, v21, -4, s98
    buffer_store_dword v21, v30, s[76:79], s12 offen offset:128
    buffer_store_dword v26, v30, s[32:35], s12 offen sc1
    buffer_store_dword v21, v30, s[32:35], s12 offen offset:128 sc1
    s_branch L_S2DONE
L_NW0:
    s_cmp_gt_u32 s85, 2
    s_cbranch_scc1 L_S2DONE
    s_cmp_eq_u32 s85, 2
    s_cbranch_scc1 L_CAN
    v_add_f32_dpp v23, v23, v23 quad_perm:[1,0,3,2] row_mask:0xf bank_mask:0xf
    s_nop 1
    v_add_f32_dpp v23, v23, v23 quad_perm:[2,3,0,1] row_mask:0xf bank_mask:0xf
    s_nop 1
    v_add_f32_dpp v23, v23, v23 row_half_mirror row_mask:0xf bank_mask:0xf
    s_nop 1
    v_add_f32_dpp v23, v23, v23 row_mirror row_mask:0xf bank_mask:0xf
    v_mov_b32 v16, v23
    s_nop 1
    v_permlane16_swap_b32 v23, v16
    v_add_f32 v23, v23, v16
    v_mov_b32 v16, v23
    s_nop 1
    v_permlane32_swap_b32 v23, v16
    v_add_f32 v23, v23, v16
    v_and_or_b32 v22, v22, -4, s98
    v_and_or_b32 v23, v23, -4, s98
    s_mov_b64 exec, 1
    buffer_store_dwordx2 v[22:23], v10, s[76:79], s13 offen
    buffer_store_dwordx2 v[22:23], v10, s[32:35], s13 offen sc1
    s_mov_b64 exec, -1
    s_branch L_S2DONE
L_CAN:
    v_mov_b32 v16, s98
    s_mov_b64 exec, 1
    buffer_store_dword v16, v10, s[76:79], s24 offen
    buffer_store_dword v16, v10, s[32:35], s24 offen sc1
    s_mov_b64 exec, -1
L_S2DONE:
    s_cmp_lg_u32 s92, 0
    s_cbranch_scc1 NOW_20
    s_setprio 0
    v_mov_b32 v16, s25
    ds_write_b32 v29, v16 offset:16384
    s_lshl_b32 s93, s85, 5
    v_add_u32 v16, s93, v8
    ds_read_b64_tr_b16 v[240:241], v16 offset:20480
    ds_read_b64_tr_b16 v[242:243], v16 offset:21504
    ds_read_b64_tr_b16 v[244:245], v16 offset:28672
    ds_read_b64_tr_b16 v[246:247], v16 offset:29696
    s_cmp_eq_u32 s31, 0
    s_cbranch_scc1 L_HOPE
    s_cmp_eq_u32 s88, 0
    s_cbranch_scc1 NOF_21
    v_lshrrev_b32 v16, 3, v1
    v_and_b32 v17, 0x70, v5
    v_lshl_add_u32 v16, v16, 10, v17
    s_lshl_b32 s93, s86, 15
    s_lshl_b32 s94, s85, 7
    s_add_u32 s93, s93, s94
    s_lshl_b32 s95, s85, 12
    s_add_u32 m0, s95, 69632
    s_nop 0
    buffer_load_dwordx4 v16, s[52:55], s93 offen nt lds
    s_add_u32 s93, s93, 8192
    s_add_u32 m0, m0, 1024
    s_nop 0
    buffer_load_dwordx4 v16, s[52:55], s93 offen nt lds
    s_add_u32 s93, s93, 8192
    s_add_u32 m0, m0, 1024
    s_nop 0
    buffer_load_dwordx4 v16, s[52:55], s93 offen nt lds
    s_add_u32 s93, s93, 8192
    s_add_u32 m0, m0, 1024
    s_nop 0
    buffer_load_dwordx4 v16, s[52:55], s93 offen nt lds
    s_lshl_b32 s94, s85, 7
    v_and_b32 v16, 31, v1
    v_lshlrev_b32 v16, 1, v16
    s_lshl_b32 s93, s86, 6
    buffer_load_ushort v252, v16, s[64:67], s93 offen
    v_lshl_add_u32 v17, v2, 2, v3
    v_lshlrev_b32 v17, 1, v17
    buffer_load_ushort v254, v17, s[60:63], s94 offen
    v_mov_b32 v20, -1
    v_mov_b32 v21, -1
    v_mov_b32 v22, -1
    v_mov_b32 v23, -1
    s_lshr_b32 s93, s85, 1
    s_lshl_b32 s93, s93, 14
    s_and_b32 s94, s85, 1
    s_lshl_b32 s94, s94, 12
    s_add_u32 s93, s93, s94
    s_add_u32 s93, s93, 122880
    s_lshl_b32 s94, s85, 14
    s_cmp_lt_u32 s86, 32
    s_cselect_b32 s93, s94, s93
    s_lshl_b32 s94, s86, 8
    s_add_u32 s93, s93, s94
    s_add_u32 s93, s93, 1638400
    v_and_b32 v204, 0xf0, v5
    v_lshl_add_u32 v204, v3, 13, v204
    v_mov_b32 v17, 268435456
    v_cmp_gt_u32 vcc, 2, v3
    s_nop 1
    v_cndmask_b32 v204, v17, v204, vcc
    buffer_store_dwordx4 v[20:23], v204, s[56:59], s93 offen sc1
    s_lshl_b32 s93, s86, 11
    s_lshl_b32 s94, s85, 8
    s_add_u32 s93, s93, s94
    s_add_u32 s93, s93, 1458176
    buffer_store_dword v20, v10, s[56:59], s93 offen sc1
    s_branch F2_22
NOF_21:
    v_and_b32 v176, 48, v5
    v_and_b32 v177, 28, v10
    s_lshl_b32 s95, s85, 4
    v_mul_u32_u24 v178, 144, v2
    v_add_u32 v178, s95, v178
    v_lshl_add_u32 v178, v3, 2, v178
    v_and_b32 v16, 31, v1
    v_lshrrev_b32 v17, 5, v1
    v_mul_u32_u24 v179, 144, v16
    v_lshl_add_u32 v179, v17, 6, v179
    v_and_b32 v16, 0x70, v10
    v_and_b32 v17, 3, v1
    v_lshl_add_u32 v16, v17, 13, v16
    v_add_u32 v18, 32768, v16
    v_cmp_gt_u32 vcc, 32, v1
    s_nop 1
    v_cndmask_b32 v16, v16, v18, vcc
    v_mov_b32 v18, 268435456
    v_cmp_gt_u32 vcc, 2, v17
    s_nop 1
    v_cndmask_b32 v180, v18, v16, vcc
    s_nop 0
    s_branch L_S3A
F2_22:
    v_lshlrev_b32 v16, 1, v1
    s_lshl_b32 s93, s84, 7
    buffer_load_ushort v253, v16, s[68:71], s93 offen
    buffer_load_ushort v248, v16, s[60:63], s93 offen
    s_waitcnt vmcnt(10)
    ds_read_b64_tr_b16 v[160:161], v6 offset:36864
    ds_read_b64_tr_b16 v[162:163], v6 offset:37120
    ds_read_b64_tr_b16 v[164:165], v6 offset:38912
    ds_read_b64_tr_b16 v[166:167], v6 offset:39168
    ds_read_b64_tr_b16 v[168:169], v6 offset:36896
    ds_read_b64_tr_b16 v[170:171], v6 offset:37152
    ds_read_b64_tr_b16 v[172:173], v6 offset:38944
    ds_read_b64_tr_b16 v[174:175], v6 offset:39200
NOW_20:
    s_cmp_eq_u32 s87, 0
    s_cbranch_scc1 L_S4
    s_cmp_lt_u32 s85, 2
    s_cbranch_scc1 SKC_23
L_S3C:
    s_branch POLL_24
RETRY_25:
    s_add_u32 s90, s90, 1
    s_cmp_lt_u32 s90, 400000
    s_cselect_b32 s97, s97, 0
POLL_24:
    buffer_load_dword v16, v177, s[56:59], s41 offen sc1
    s_waitcnt vmcnt(0)
    v_and_b32 v24, s97, v16
    v_cmp_ne_u32 vcc, 0, v24
    s_cbranch_vccnz RETRY_25
SKC_23:
L_S3R:
    buffer_load_dwordx4 v[16:19], v176, s[56:59], s40 offen sc1
    buffer_load_dwordx4 v[208:211], v5, s[56:59], s29 offen sc1
    buffer_load_dwordx4 v[212:215], v5, s[56:59], s29 offen offset:1024 sc1
    s_add_u32 s90, s90, 1
    s_cmp_lt_u32 s90, 400000
    s_cselect_b32 s97, s97, 0
    s_waitcnt vmcnt(2)
    v_max_f32 v25, v16, v18
    v_or3_b32 v24, v16, v17, v18
    v_or_b32 v24, v24, v19
    v_max_f32_dpp v25, v25, v25 quad_perm:[1,0,3,2] row_mask:0xf bank_mask:0xf
    s_nop 1
    v_max_f32_dpp v25, v25, v25 quad_perm:[2,3,0,1] row_mask:0xf bank_mask:0xf
    v_sub_f32 v16, v16, v25
    v_sub_f32 v18, v18, v25
    v_exp_f32 v16, v16
    v_exp_f32 v18, v18
    v_mul_f32 v26, v16, v17
    v_fmac_f32 v26, v18, v19
    v_cndmask_b32_e64 v16, v16, v18, s[16:17]
    s_waitcnt vmcnt(1) lgkmcnt(0)
    v_mfma_f32_16x16x32_bf16 v[224:227], v[208:211], v[160:163], 0
    v_mfma_f32_16x16x32_bf16 v[228:231], v[208:211], v[168:171], 0
    v_add_f32_dpp v26, v26, v26 quad_perm:[1,0,3,2] row_mask:0xf bank_mask:0xf
    s_waitcnt vmcnt(0)
    v_mfma_f32_16x16x32_bf16 v[224:227], v[212:215], v[164:167], v[224:227]
    v_mfma_f32_16x16x32_bf16 v[228:231], v[212:215], v[172:175], v[228:231]
    v_add_f32_dpp v26, v26, v26 quad_perm:[2,3,0,1] row_mask:0xf bank_mask:0xf
    v_or3_b32 v24, v24, v208, v209
    v_or3_b32 v24, v24, v210, v211
    v_or3_b32 v24, v24, v212, v213
    v_or3_b32 v24, v24, v214, v215
    v_rcp_f32 v26, v26
    v_and_b32 v24, s97, v24
    v_cmp_ne_u32 vcc, 0, v24
    v_mov_b32_dpp v20, v16 quad_perm:[0,0,0,0] row_mask:0xf bank_mask:0xf
    v_mov_b32_dpp v21, v16 quad_perm:[1,1,1,1] row_mask:0xf bank_mask:0xf
    v_mov_b32_dpp v22, v16 quad_perm:[2,2,2,2] row_mask:0xf bank_mask:0xf
    v_mov_b32_dpp v23, v16 quad_perm:[3,3,3,3] row_mask:0xf bank_mask:0xf
    s_cbranch_vccnz L_S3R
L_S3OK:
    v_pk_mul_f32 v[16:17], v[224:225], v[20:21]
    v_pk_mul_f32 v[18:19], v[228:229], v[20:21]
    v_pk_fma_f32 v[16:17], v[226:227], v[22:23], v[16:17]
    v_pk_fma_f32 v[18:19], v[230:231], v[22:23], v[18:19]
    v_add_f32 v16, v16, v17
    v_add_f32 v17, v18, v19
    v_pk_mul_f32 v[16:17], v[16:17], v[26:27] op_sel:[0,0] op_sel_hi:[1,0]
    ds_write2st64_b32 v178, v16, v17 offset0:20 offset1:29
    s_cmp_lg_u32 s85, 0
    s_waitcnt lgkmcnt(0)
    s_barrier
    s_cbranch_scc1 L_HOPE
    ds_read_b128 v[208:211], v179 offset:5120
    ds_read_b128 v[212:215], v179 offset:5136
    ds_read_b128 v[216:219], v179 offset:5152
    ds_read_b128 v[220:223], v179 offset:5168
    s_waitcnt lgkmcnt(3)
    v_pk_add_f32 v[16:17], v[208:209], v[210:211]
    s_waitcnt lgkmcnt(2)
    v_pk_add_f32 v[18:19], v[212:213], v[214:215]
    v_pk_add_f32 v[16:17], v[16:17], v[18:19]
    s_waitcnt lgkmcnt(1)
    v_pk_add_f32 v[18:19], v[216:217], v[218:219]
    v_pk_add_f32 v[16:17], v[16:17], v[18:19]
    s_waitcnt lgkmcnt(0)
    v_pk_add_f32 v[18:19], v[220:221], v[222:223]
    v_pk_add_f32 v[16:17], v[16:17], v[18:19]
    v_add_f32 v18, v16, v17
    v_add_f32 v19, v16, v17
    s_nop 1
    v_permlane32_swap_b32 v18, v19
    v_add_f32 v20, v18, v19
    v_and_or_b32 v20, v20, -4, s98
    s_nop 1
    v_mov_b32_dpp v16, v20 quad_perm:[0,0,0,0] row_mask:0xf bank_mask:0xf
    v_mov_b32_dpp v17, v20 quad_perm:[1,1,1,1] row_mask:0xf bank_mask:0xf
    v_mov_b32_dpp v18, v20 quad_perm:[2,2,2,2] row_mask:0xf bank_mask:0xf
    v_mov_b32_dpp v19, v20 quad_perm:[3,3,3,3] row_mask:0xf bank_mask:0xf
    buffer_store_dwordx4 v[16:19], v180, s[56:59], s42 offen sc1
    s_add_u32 s42, s42, 1048576
    s_branch L_HOPE
L_S3A:
    s_waitcnt vmcnt(0)
    buffer_load_dwordx4 v[16:19], v176, s[56:59], s40 offen sc1
    buffer_load_dwordx4 v[208:211], v5, s[56:59], s29 offen sc1
    buffer_load_dwordx4 v[212:215], v5, s[56:59], s29 offen offset:1024 sc1
    ds_read_b64_tr_b16 v[160:161], v6 offset:36864
    ds_read_b64_tr_b16 v[162:163], v6 offset:37120
    ds_read_b64_tr_b16 v[164:165], v6 offset:38912
    ds_read_b64_tr_b16 v[166:167], v6 offset:39168
    ds_read_b64_tr_b16 v[168:169], v6 offset:36896
    ds_read_b64_tr_b16 v[170:171], v6 offset:37152
    ds_read_b64_tr_b16 v[172:173], v6 offset:38944
    ds_read_b64_tr_b16 v[174:175], v6 offset:39200
    s_waitcnt vmcnt(2)
    v_max_f32 v25, v16, v18
    v_or3_b32 v24, v16, v17, v18
    v_or_b32 v24, v24, v19
    v_max_f32_dpp v25, v25, v25 quad_perm:[1,0,3,2] row_mask:0xf bank_mask:0xf
    s_nop 1
    v_max_f32_dpp v25, v25, v25 quad_perm:[2,3,0,1] row_mask:0xf bank_mask:0xf
    v_sub_f32 v16, v16, v25
    v_sub_f32 v18, v18, v25
    v_exp_f32 v16, v16
    v_exp_f32 v18, v18
    v_mul_f32 v26, v16, v17
    v_fmac_f32 v26, v18, v19
    v_cndmask_b32_e64 v16, v16, v18, s[16:17]
    s_waitcnt vmcnt(1) lgkmcnt(0)
    v_mfma_f32_16x16x32_bf16 v[224:227], v[208:211], v[160:163], 0
    v_mfma_f32_16x16x32_bf16 v[228:231], v[208:211], v[168:171], 0
    v_add_f32_dpp v26, v26, v26 quad_perm:[1,0,3,2] row_mask:0xf bank_mask:0xf
    s_waitcnt vmcnt(0)
    v_mfma_f32_16x16x32_bf16 v[224:227], v[212:215], v[164:167], v[224:227]
    v_mfma_f32_16x16x32_bf16 v[228:231], v[212:215], v[172:175], v[228:231]
    v_add_f32_dpp v26, v26, v26 quad_perm:[2,3,0,1] row_mask:0xf bank_mask:0xf
    v_or3_b32 v24, v24, v208, v209
    v_or3_b32 v24, v24, v210, v211
    v_or3_b32 v24, v24, v212, v213
    v_or3_b32 v24, v24, v214, v215
    v_rcp_f32 v26, v26
    v_and_b32 v24, s97, v24
    v_cmp_ne_u32 vcc, 0, v24
    v_mov_b32_dpp v20, v16 quad_perm:[0,0,0,0] row_mask:0xf bank_mask:0xf
    v_mov_b32_dpp v21, v16 quad_perm:[1,1,1,1] row_mask:0xf bank_mask:0xf
    v_mov_b32_dpp v22, v16 quad_perm:[2,2,2,2] row_mask:0xf bank_mask:0xf
    v_mov_b32_dpp v23, v16 quad_perm:[3,3,3,3] row_mask:0xf bank_mask:0xf
    s_cbranch_vccnz L_S3C
    s_branch L_S3OK
L_S4:
    s_cmp_eq_u32 s88, 0
    s_cbranch_scc1 L_HOPE
    s_cmp_lg_u32 s92, 0
    s_cbranch_scc1 NOW_26
    v_add_u32 v205, 69632, v7
    v_mov_b32 v20, 0x3f803f80
    v_mov_b32 v21, 0x3f803f80
    v_mov_b32 v22, 0x3f803f80
    v_mov_b32 v23, 0x3f803f80
    v_mov_b32 v224, 0
    v_mov_b32 v226, 0
    v_mov_b32 v228, 0
    v_mov_b32 v230, 0
    s_waitcnt lgkmcnt(0)
    v_smfmac_f32_16x16x64_bf16 v[224:227], v[20:23], v[160:167], v4
    v_smfmac_f32_16x16x64_bf16 v[228:231], v[20:23], v[168:175], v4
    s_mov_b32 s91, 268435456
    v_lshlrev_b32 v16, 1, v1
    s_lshl_b32 s93, s84, 7
    s_lshl_b32 s22, s85, 6
    s_lshl_b32 s23, s82, 9
    s_add_u32 s22, s22, s23
    s_waitcnt lgkmcnt(0)
    v_add_u32 v6, s22, v10
    v_mov_b32 v17, 268435456
    v_cndmask_b32_e64 v6, v17, v6, s[4:5]
    s_lshl_b32 s22, s82, 3
    s_add_u32 s22, s22, 393216
    s_cmp_eq_u32 s85, 0
    s_cselect_b32 s22, s22, 268435456
    v_writelane_b32 v6, s22, 16
    s_add_u32 s22, s22, 4
    v_writelane_b32 v6, s22, 32
    v_bfe_u32 v7, v1, 3, 1
    v_lshlrev_b32 v7, 7, v7
    v_bfe_u32 v17, v1, 4, 1
    v_lshl_add_u32 v7, v17, 5, v7
    v_and_b32 v17, 7, v1
    v_lshl_add_u32 v7, v17, 2, v7
    v_lshrrev_b32 v18, 5, v1
    v_lshl_add_u32 v7, v18, 6, v7
    s_lshl_b32 s22, s83, 6
    s_add_u32 s22, s22, 393216
    v_lshl_add_u32 v8, v17, 3, s22
    s_lshl_b32 s22, s84, 8
    s_add_u32 s22, s22, 102400
    v_add_u32 v2, s22, v10
    v_add_f32 v16, v224, v226
    v_add_f32 v17, v228, v230
    v_cndmask_b32_e64 v16, v16, v17, s[16:17]
    ds_write_b32 v29, v16 offset:12288
    s_branch XOK_27
NOW_26:
    s_lshl_b32 s93, s85, 8
    s_add_u32 s93, s93, 398336
    v_and_b32 v16, 0xf0, v5
    v_lshl_add_u32 v16, v3, 2, v16
    s_nop 0
    s_branch POLL_28
RETRY_29:
    s_add_u32 s90, s90, 1
    s_cmp_lt_u32 s90, 400000
    s_cselect_b32 s97, s97, 0
POLL_28:
    buffer_load_dword v254, v16, s[56:59], s93 offen sc1
    s_waitcnt vmcnt(0)
    v_and_b32 v24, s97, v254
    v_cmp_ne_u32 vcc, 0, v24
    s_cbranch_vccnz RETRY_29
XOK_27:
    s_lshr_b32 s93, s85, 2
    s_lshl_b32 s93, s93, 14
    s_and_b32 s23, s85, 3
    s_lshl_b32 s23, s23, 11
    s_add_u32 s93, s93, s23
    s_add_u32 s93, s93, s3
    s_add_u32 s93, s93, s0
    s_add_u32 s93, s93, 442368
    s_lshr_b32 s100, s85, 1
    s_lshl_b32 s100, s100, 14
    s_and_b32 s23, s85, 1
    s_lshl_b32 s23, s23, 12
    s_add_u32 s100, s100, s23
    s_add_u32 s100, s100, 122880
    s_lshl_b32 s23, s85, 14
    s_cmp_lt_u32 s86, 32
    s_cselect_b32 s100, s23, s100
    s_lshl_b32 s23, s86, 8
    s_add_u32 s100, s100, s23
    s_add_u32 s100, s100, s3
    s_add_u32 s100, s100, 589824
    s_lshl_b32 s23, s85, 7
    s_add_u32 s23, s23, 18432
    v_and_b32 v16, 0x30, v9
    v_add_u32 v16, 19456, v16
    v_bfe_u32 v17, v10, 2, 1
    v_lshrrev_b32 v18, 1, v3
    v_mov_b32 v19, 288
    v_cmp_eq_u32 vcc, v17, v18
    s_nop 1
    v_cndmask_b32 v201, v19, v16, vcc
    v_mov_b32 v232, 0
    v_mov_b32 v233, 0
    v_mov_b32 v234, 0
    v_mov_b32 v235, 0
    v_mov_b32 v236, 0
    v_mov_b32 v237, 0
    v_mov_b32 v238, 0
    v_mov_b32 v239, 0
    v_and_b32 v16, 0xf0, v5
    v_lshl_add_u32 v16, v3, 2, v16
    s_lshl_b32 s22, s85, 8
    s_add_u32 s22, s22, 102400
    v_add_u32 v202, s22, v16
    v_bfe_u32 v16, v10, 4, 2
    v_lshl_add_u32 v16, v16, 5, s23
    v_lshrrev_b32 v17, 1, v3
    v_lshl_add_u32 v16, v17, 4, v16
    v_and_b32 v17, 12, v10
    v_add_u32 v16, v16, v17
    v_and_b32 v17, 1, v3
    v_lshl_add_u32 v203, v17, 1, v16
    v_and_b32 v204, 0xf0, v5
    v_lshl_add_u32 v204, v3, 13, v204
    v_mov_b32 v17, 268435456
    v_cmp_gt_u32 vcc, 2, v3
    s_nop 1
    v_cndmask_b32 v204, v17, v204, vcc
    v_mov_b32 v224, 0
    v_mov_b32 v226, 0
    v_mov_b32 v228, 0
    v_mov_b32 v230, 0
    s_add_u32 s94, s3, s0
    s_add_u32 s94, s94, 589824
    s_lshl_b32 s22, s85, 10
    s_add_u32 s94, s94, s22
    s_lshl_b32 s22, s84, 14
    s_add_u32 s22, s22, s94
    s_lshr_b32 s23, s84, 1
    s_lshl_b32 s23, s23, 14
    s_add_u32 s94, s94, s23
    s_and_b32 s23, s84, 1
    s_lshl_b32 s23, s23, 12
    s_add_u32 s23, s23, s94
    s_add_u32 s23, s23, 131072
    s_cmp_lt_u32 s85, 3
    s_cselect_b32 s23, s23, 268435456
    s_cmp_lg_u32 s85, 0
    s_cbranch_scc1 TC_30
    s_cmp_eq_u32 s92, 0
    s_cbranch_scc1 TC2_31
    s_lshl_b32 s94, s80, 7
    s_add_u32 s94, s94, 397312
    v_and_b32 v17, 124, v10
    s_nop 0
    s_branch POLL_32
RETRY_33:
    s_add_u32 s90, s90, 1
    s_cmp_lt_u32 s90, 400000
    s_cselect_b32 s97, s97, 0
POLL_32:
    buffer_load_dword v16, v17, s[56:59], s94 offen sc1
    s_waitcnt vmcnt(0)
    v_and_b32 v24, s97, v16
    v_cmp_ne_u32 vcc, 0, v24
    s_cbranch_vccnz RETRY_33
    s_sleep 13
    s_branch TC_30
TC2_31:
    s_add_u32 s94, s0, 475136
    v_lshrrev_b32 v17, 1, v28
    s_mov_b64 exec, 0xff
    s_branch POLL_34
RETRY_35:
    s_add_u32 s90, s90, 1
    s_cmp_lt_u32 s90, 400000
    s_cselect_b32 s97, s97, 0
POLL_34:
    buffer_load_dword v16, v17, s[56:59], s94 offen sc1
    s_waitcnt vmcnt(0)
    v_and_b32 v24, s97, v16
    v_cmp_ne_u32 vcc, 0, v24
    s_cbranch_vccnz RETRY_35
    s_mov_b64 exec, -1
TC_30:
    s_waitcnt lgkmcnt(0)
    s_barrier
    buffer_load_dwordx4 v[216:219], v5, s[56:59], s93 offen offset:0 sc1
    buffer_load_dwordx4 v[220:223], v5, s[56:59], s93 offen offset:1024 sc1
    s_cmp_lg_u32 s92, 0
    s_cbranch_scc1 C1_37
    ds_read2st64_b32 v[16:17], v10 offset0:48 offset1:49
    ds_read2st64_b32 v[18:19], v10 offset0:50 offset1:51
    ds_read2st64_b32 v[20:21], v10 offset0:52 offset1:53
    ds_read2st64_b32 v[22:23], v10 offset0:54 offset1:55
    s_waitcnt lgkmcnt(0)
    v_pk_add_f32 v[16:17], v[16:17], v[18:19]
    v_pk_add_f32 v[20:21], v[20:21], v[22:23]
    v_pk_add_f32 v[16:17], v[16:17], v[20:21]
    v_add_f32 v0, v16, v17
    s_waitcnt vmcnt(2)
    ds_read_b64_tr_b16 v[176:177], v205 offset:0
    ds_read_b64_tr_b16 v[178:179], v205 offset:512
    ds_read_b64_tr_b16 v[180:181], v205 offset:32
    ds_read_b64_tr_b16 v[182:183], v205 offset:544
    ds_read_b64_tr_b16 v[184:185], v205 offset:64
    ds_read_b64_tr_b16 v[186:187], v205 offset:576
    ds_read_b64_tr_b16 v[188:189], v205 offset:96
    ds_read_b64_tr_b16 v[190:191], v205 offset:608
    v_lshlrev_b32 v252, 16, v252
    v_lshlrev_b32 v254, 16, v254
    v_lshlrev_b32 v1, 16, v248
C1_37:
    s_nop 0
    s_branch MP_38
MR_39:
    s_add_u32 s90, s90, 1
    s_cmp_lt_u32 s90, 400000
    s_cselect_b32 s97, s97, 0
    buffer_load_dwordx4 v[216:219], v5, s[56:59], s93 offen offset:0 sc1
    buffer_load_dwordx4 v[220:223], v5, s[56:59], s93 offen offset:1024 sc1
MP_38:
    s_waitcnt vmcnt(0)
    v_pk_add_f32 v[20:21], v[216:217], v[220:221]
    v_pk_add_f32 v[22:23], v[218:219], v[222:223]
    s_nop 1
    v_permlane32_swap_b32 v20, v22
    v_permlane32_swap_b32 v21, v23
    v_pk_add_f32 v[20:21], v[20:21], v[22:23]
    s_nop 1
    v_permlane16_swap_b32 v20, v21
    v_add_f32 v24, v20, v21
    v_cvt_pk_bf16_f32 v24, v24, v24
    v_lshlrev_b32 v24, 16, v24
    v_add_f32 v25, v24, v254
    v_cvt_pk_bf16_f32 v25, v25, v25
    ds_write_b16 v203, v25
    ds_read_b128 v[208:211], v9
    v_lshlrev_b32 v25, 16, v25
    v_mul_f32 v26, v25, v25
    v_or3_b32 v214, v216, v217, v218
    v_or3_b32 v214, v214, v219, v220
    v_or3_b32 v214, v214, v221, v222
    v_or_b32 v214, v214, v223
    v_and_b32 v214, s97, v214
    v_cmp_ne_u32 vcc, 0, v214
    s_nop 0
    s_cbranch_vccnz MR_39
MDONE_36:
    v_permlane16_swap_b32 v25, v26
    v_add_f32 v25, v25, v26
    s_waitcnt lgkmcnt(0)
    v_smfmac_f32_16x16x64_bf16 v[224:227], v[208:211], v[160:167], v4
    v_add_f32_dpp v25, v25, v25 quad_perm:[1,0,3,2] row_mask:0xf bank_mask:0xf
    v_smfmac_f32_16x16x64_bf16 v[228:231], v[208:211], v[168:175], v4
    s_nop 0
    v_add_f32_dpp v25, v25, v25 quad_perm:[2,3,0,1] row_mask:0xf bank_mask:0xf
    ds_write_b32 v202, v24
    s_nop 0
    v_add_f32_dpp v25, v25, v25 row_half_mirror row_mask:0xf bank_mask:0xf
    s_nop 1
    v_add_f32_dpp v25, v25, v25 row_mirror row_mask:0xf bank_mask:0xf
    v_mov_b32 v18, v25
    v_add_f32 v16, v224, v226
    v_add_f32 v17, v228, v230
    v_permlane32_swap_b32 v25, v18
    v_add_f32 v25, v25, v18
    v_cndmask_b32_e64 v16, v16, v17, s[16:17]
    v_cndmask_b32_e64 v16, v16, v25, s[6:7]
    ds_write_b32 v29, v16 offset:10240
    s_cmp_eq_u32 s85, 0
    s_cbranch_scc1 H0_40
    s_waitcnt lgkmcnt(0)
    s_barrier
    s_branch H1_41
H0_40:
    s_waitcnt lgkmcnt(0)
    s_barrier
    ds_read2st64_b32 v[16:17], v10 offset0:40 offset1:41
    ds_read2st64_b32 v[18:19], v10 offset0:42 offset1:43
    ds_read2st64_b32 v[20:21], v10 offset0:44 offset1:45
    ds_read2st64_b32 v[22:23], v10 offset0:46 offset1:47
    v_mov_b32 v26, 0xc0135761
    v_mov_b32 v25, 0x3b000000
    s_waitcnt lgkmcnt(2)
    v_pk_add_f32 v[16:17], v[16:17], v[18:19]
    s_waitcnt lgkmcnt(0)
    v_pk_add_f32 v[20:21], v[20:21], v[22:23]
    v_pk_add_f32 v[16:17], v[16:17], v[20:21]
    v_add_f32 v20, v16, v17
    s_nop 0
    v_readlane_b32 s99, v20, 32
    v_readlane_b32 s101, v20, 48
    s_nop 0
    v_mul_f32 v17, s99, v25
    v_mul_f32 v16, s101, v25
    v_fma_f32 v16, -v17, v17, v16
    v_max_f32 v16, 0, v16
    v_add_f32 v16, 0x3727c5ac, v16
    v_rsq_f32 v16, v16
    v_fma_f32 v20, -v17, v0, v20
    v_mul_f32 v20, v16, v20
    v_cvt_pk_bf16_f32 v20, v20, v20
    v_lshlrev_b32 v20, 16, v20
    v_add_f32 v20, v20, v252
    v_cvt_pk_bf16_f32 v20, v20, v20
    v_lshlrev_b32 v20, 16, v20
    v_mul_f32 v21, v20, v20
    v_fmac_f32 v26, 0xbdd2d3e8, v21
    v_mul_f32 v22, v26, v20
    v_exp_f32 v22, v22
    s_nop 0
    v_add_f32 v22, 1.0, v22
    v_rcp_f32 v22, v22
    s_nop 0
    v_mul_f32 v20, v20, v22
    v_cvt_pk_bf16_f32 v20, v20, v20
    ds_write_b16 v255, v20 offset:1024
    s_waitcnt lgkmcnt(0)
H1_41:
    s_barrier
    ds_read_b128 v[20:23], v201
    s_waitcnt lgkmcnt(0)
    v_smfmac_f32_16x16x64_bf16 v[232:235], v[20:23], v[176:183], v4
    v_smfmac_f32_16x16x64_bf16 v[236:239], v[20:23], v[184:191], v4
    s_nop 6
    v_pk_add_f32 v[16:17], v[232:233], v[234:235]
    v_pk_add_f32 v[18:19], v[236:237], v[238:239]
    v_and_or_b32 v16, v16, -4, s98
    v_and_or_b32 v17, v17, -4, s98
    v_and_or_b32 v18, v18, -4, s98
    v_and_or_b32 v19, v19, -4, s98
    buffer_store_dwordx4 v[16:19], v204, s[56:59], s100 offen sc1
    s_cmp_lg_u32 s92, 0
    s_cbranch_scc1 L_FIN
    v_mov_b32 v224, 0
    v_mov_b32 v225, 0
    v_mov_b32 v226, 0
    v_mov_b32 v227, 0
    v_mov_b32 v228, 0
    v_mov_b32 v229, 0
    v_mov_b32 v230, 0
    v_mov_b32 v231, 0
    v_mov_b32 v232, 0
    v_mov_b32 v234, 0
    v_mov_b32 v236, 0
    v_mov_b32 v238, 0
    v_mov_b32 v200, 0
    v_mov_b32 v201, 0
    v_mov_b32 v202, 0
    v_mov_b32 v203, 0
    v_mov_b32 v204, 0
    v_mov_b32 v205, 0
    s_cmp_lg_u32 s85, 0
    s_cbranch_scc1 L_S1W
    v_mov_b32 v17, 268435456
    v_cndmask_b32_e64 v25, v5, v17, s[10:11]
    s_add_u32 s100, s43, 131072
    buffer_load_dwordx4 v[208:211], v5, s[56:59], s100 offen offset:0 sc1
    buffer_load_dwordx4 v[212:215], v5, s[56:59], s100 offen offset:1024 sc1
    buffer_load_dwordx4 v[216:219], v5, s[56:59], s100 offen offset:2048 sc1
    buffer_load_dwordx4 v[220:223], v5, s[56:59], s100 offen offset:3072 sc1
    s_waitcnt vmcnt(0)
    v_pk_add_f32 v[248:249], v[208:209], v[212:213]
    v_pk_add_f32 v[250:251], v[210:211], v[214:215]
    v_pk_add_f32 v[20:21], v[216:217], v[220:221]
    v_pk_add_f32 v[22:23], v[218:219], v[222:223]
    v_pk_add_f32 v[248:249], v[248:249], v[20:21]
    v_pk_add_f32 v[250:251], v[250:251], v[22:23]
    s_nop 1
    v_permlane32_swap_b32 v248, v250
    v_permlane32_swap_b32 v249, v251
    v_pk_add_f32 v[248:249], v[248:249], v[250:251]
    s_nop 0
    s_branch L_HOPE2
L_HOPE:
    s_cmp_lg_u32 s92, 0
    s_cbranch_scc1 L_HOPE1
    s_lshl_b32 s93, s81, 3
    s_or_b32 s93, s93, s85
    s_cmp_lg_u32 s93, 251
    s_cbranch_scc1 NCC_43
    s_lshl_b32 s94, s80, 7
    s_add_u32 s93, s94, 475136
    s_add_u32 s94, s94, 397312
    v_and_b32 v17, 124, v10
    s_nop 0
    s_branch POLL_44
RETRY_45:
    s_add_u32 s90, s90, 1
    s_cmp_lt_u32 s90, 400000
    s_cselect_b32 s97, s97, 0
POLL_44:
    buffer_load_dword v16, v17, s[56:59], s94 offen sc1
    s_waitcnt vmcnt(0)
    v_and_b32 v24, s97, v16
    v_cmp_ne_u32 vcc, 0, v24
    s_cbranch_vccnz RETRY_45
    v_lshlrev_b32 v17, 11, v10
    s_mov_b64 exec, 3
    buffer_store_dword v16, v17, s[56:59], s93 offen sc1
    s_mov_b64 exec, -1
NCC_43:
    s_mov_b32 s91, 268435456
    v_lshlrev_b32 v16, 1, v1
    s_lshl_b32 s93, s84, 7
    buffer_load_ushort v253, v16, s[68:71], s93 offen
    s_lshl_b32 s22, s85, 6
    s_lshl_b32 s23, s82, 9
    s_add_u32 s22, s22, s23
    s_waitcnt lgkmcnt(0)
    v_add_u32 v6, s22, v10
    v_mov_b32 v17, 268435456
    v_cndmask_b32_e64 v6, v17, v6, s[4:5]
    s_lshl_b32 s22, s82, 3
    s_add_u32 s22, s22, 393216
    s_cmp_eq_u32 s85, 0
    s_cselect_b32 s22, s22, 268435456
    v_writelane_b32 v6, s22, 16
    s_add_u32 s22, s22, 4
    v_writelane_b32 v6, s22, 32
    v_bfe_u32 v7, v1, 3, 1
    v_lshlrev_b32 v7, 7, v7
    v_bfe_u32 v17, v1, 4, 1
    v_lshl_add_u32 v7, v17, 5, v7
    v_and_b32 v17, 7, v1
    v_lshl_add_u32 v7, v17, 2, v7
    v_lshrrev_b32 v18, 5, v1
    v_lshl_add_u32 v7, v18, 6, v7
    s_lshl_b32 s22, s83, 6
    s_add_u32 s22, s22, 393216
    v_lshl_add_u32 v8, v17, 3, s22
    s_lshl_b32 s22, s84, 8
    s_add_u32 s22, s22, 102400
    v_add_u32 v2, s22, v10
    buffer_load_short_d16_hi v1, v16, s[60:63], s93 offen
    s_cmp_lg_u32 s85, 1
    s_cbranch_scc1 NWM_46
    buffer_load_dwordx2 v[18:19], v8, s[56:59], 0 offen sc1
    buffer_load_dwordx4 v[208:211], v5, s[56:59], s43 offen offset:0 sc1
    buffer_load_dwordx4 v[212:215], v5, s[56:59], s43 offen offset:1024 sc1
    buffer_load_dwordx4 v[216:219], v5, s[56:59], s43 offen offset:2048 sc1
    buffer_load_dwordx4 v[220:223], v5, s[56:59], s43 offen offset:3072 sc1
    s_add_u32 s100, s43, 131072
    buffer_load_dwordx4 v[208:211], v5, s[76:79], s100 offen offset:0 sc1
    buffer_load_dwordx4 v[212:215], v5, s[76:79], s100 offen offset:1024 sc1
    buffer_load_dwordx4 v[216:219], v5, s[76:79], s100 offen offset:2048 sc1
    buffer_load_dwordx4 v[220:223], v5, s[76:79], s100 offen offset:3072 sc1
NWM_46:
    v_mov_b32 v224, 0
    v_mov_b32 v225, 0
    v_mov_b32 v226, 0
    v_mov_b32 v227, 0
    v_mov_b32 v228, 0
    v_mov_b32 v229, 0
    v_mov_b32 v230, 0
    v_mov_b32 v231, 0
    v_mov_b32 v232, 0
    v_mov_b32 v234, 0
    v_mov_b32 v236, 0
    v_mov_b32 v238, 0
    s_cmp_lg_u32 s85, 0
    s_cbranch_scc1 L_S1W
    s_branch GOE_42
L_HOPE1:
    s_cmp_lg_u32 s85, 0
    s_cbranch_scc1 L_FIN
    s_cmp_ge_u32 s82, 8
    s_cbranch_scc1 L_FIN
    s_or_b32 s93, s82, s85
    s_mov_b32 s94, 561152
    s_cselect_b32 s93, 268435456, s94
    v_mov_b32 v19, s28
    s_mov_b64 exec, 1
    buffer_store_dword v19, v10, s[56:59], s93 offen sc1
    s_mov_b64 exec, -1
    s_lshl_b32 s91, s84, 7
    s_cmp_eq_u32 s85, 0
    s_cselect_b32 s91, s91, 268435456
GOE_42:
    s_add_u32 s94, s3, s0
    s_add_u32 s94, s94, 589824
    s_lshl_b32 s22, s85, 10
    s_add_u32 s94, s94, s22
    s_lshl_b32 s22, s84, 14
    s_add_u32 s22, s22, s94
    s_lshr_b32 s23, s84, 1
    s_lshl_b32 s23, s23, 14
    s_add_u32 s94, s94, s23
    s_and_b32 s23, s84, 1
    s_lshl_b32 s23, s23, 12
    s_add_u32 s23, s23, s94
    s_add_u32 s23, s23, 131072
    s_cmp_lt_u32 s85, 3
    s_cselect_b32 s23, s23, 268435456
    v_mov_b32 v17, 268435456
    v_cndmask_b32_e64 v25, v5, v17, s[10:11]
    s_lshr_b32 s96, s84, 2
    s_lshl_b32 s96, s96, 14
    s_and_b32 s100, s84, 3
    s_lshl_b32 s100, s100, 11
    s_add_u32 s96, s96, s100
    s_add_u32 s96, s96, s3
    s_add_u32 s96, s96, s0
    s_add_u32 s96, s96, 409600
    s_branch POLL_47
RETRY_48:
    s_sleep 1
    s_add_u32 s90, s90, 1
    s_cmp_lt_u32 s90, 400000
    s_cselect_b32 s97, s97, 0
POLL_47:
    buffer_load_dwordx4 v[208:211], v5, s[56:59], s96 offen offset:0 sc1
    buffer_load_dwordx4 v[212:215], v5, s[56:59], s96 offen offset:1024 sc1
    s_waitcnt vmcnt(0)
    v_or3_b32 v24, v208, v209, v210
    v_or3_b32 v24, v24, v211, v212
    v_or3_b32 v24, v24, v213, v214
    v_or_b32 v24, v24, v215
    v_and_b32 v24, s97, v24
    v_cmp_ne_u32 vcc, 0, v24
    s_cbranch_vccnz RETRY_48
    v_pk_add_f32 v[20:21], v[208:209], v[212:213]
    v_pk_add_f32 v[22:23], v[210:211], v[214:215]
    s_nop 1
    v_permlane32_swap_b32 v20, v22
    v_permlane32_swap_b32 v21, v23
    v_pk_add_f32 v[20:21], v[20:21], v[22:23]
    s_nop 1
    v_permlane16_swap_b32 v20, v21
    v_add_f32 v16, v20, v21
    v_cvt_pk_bf16_f32 v16, v16, v16
    v_lshlrev_b32 v16, 16, v16
    v_and_b32 v17, 0xf0, v5
    v_lshl_add_u32 v17, v3, 2, v17
    s_lshl_b32 s96, s84, 8
    s_add_u32 s96, s96, 102400
    v_add_u32 v17, s96, v17
    ds_write_b32 v17, v16
    s_cmp_lg_u32 s92, 0
    s_cbranch_scc1 NOCS_49
    s_add_u32 s100, s43, 131072
    buffer_load_dwordx4 v[208:211], v5, s[56:59], s100 offen offset:0 sc1
    buffer_load_dwordx4 v[212:215], v5, s[56:59], s100 offen offset:1024 sc1
    buffer_load_dwordx4 v[216:219], v5, s[56:59], s100 offen offset:2048 sc1
    buffer_load_dwordx4 v[220:223], v5, s[56:59], s100 offen offset:3072 sc1
    s_waitcnt vmcnt(0)
    v_pk_add_f32 v[248:249], v[208:209], v[212:213]
    v_pk_add_f32 v[250:251], v[210:211], v[214:215]
    v_pk_add_f32 v[20:21], v[216:217], v[220:221]
    v_pk_add_f32 v[22:23], v[218:219], v[222:223]
    v_pk_add_f32 v[248:249], v[248:249], v[20:21]
    v_pk_add_f32 v[250:251], v[250:251], v[22:23]
    s_nop 1
    v_permlane32_swap_b32 v248, v250
    v_permlane32_swap_b32 v249, v251
    v_pk_add_f32 v[248:249], v[248:249], v[250:251]
    s_sleep 20
    s_branch NOCS_50
NOCS_49:
    s_sleep 23
NOCS_50:
L_HOPE2:
    ds_read_b32 v26, v2
    s_add_u32 s100, s22, 4096
    buffer_load_dwordx4 v[208:211], v5, s[56:59], s22 offen offset:0 sc1
    buffer_load_dwordx4 v[212:215], v5, s[56:59], s22 offen offset:1024 sc1
    buffer_load_dwordx4 v[216:219], v5, s[56:59], s22 offen offset:2048 sc1
    buffer_load_dwordx4 v[220:223], v5, s[56:59], s22 offen offset:3072 sc1
    buffer_load_dwordx4 v[224:227], v5, s[56:59], s100 offen offset:0 sc1
    buffer_load_dwordx4 v[228:231], v5, s[56:59], s100 offen offset:1024 sc1
    buffer_load_dwordx4 v[232:235], v5, s[56:59], s100 offen offset:2048 sc1
    buffer_load_dwordx4 v[192:195], v5, s[56:59], s100 offen offset:3072 sc1
    buffer_load_dwordx4 v[196:199], v5, s[56:59], s23 offen offset:0 sc1
    buffer_load_dwordx4 v[200:203], v5, s[56:59], s23 offen offset:1024 sc1
    buffer_load_dwordx4 v[204:207], v25, s[56:59], s23 offen offset:2048 sc1
    v_and_b32 v1, 0xffff0000, v1
    v_lshlrev_b32 v19, 16, v253
    v_lshrrev_b32 v18, 1, v10
    s_waitcnt lgkmcnt(0)
    v_add_f32 v26, v26, v1
    v_cvt_pk_bf16_f32 v26, v26, v26
    v_lshlrev_b32 v26, 16, v26
    s_nop 0
    s_branch E_51
ER_52:
    s_add_u32 s90, s90, 1
    s_cmp_lt_u32 s90, 400000
    s_cselect_b32 s97, s97, 0
    buffer_load_dwordx4 v[208:211], v5, s[56:59], s22 offen offset:0 sc1
    buffer_load_dwordx4 v[212:215], v5, s[56:59], s22 offen offset:1024 sc1
    buffer_load_dwordx4 v[216:219], v5, s[56:59], s22 offen offset:2048 sc1
    buffer_load_dwordx4 v[220:223], v5, s[56:59], s22 offen offset:3072 sc1
    buffer_load_dwordx4 v[224:227], v5, s[56:59], s100 offen offset:0 sc1
    buffer_load_dwordx4 v[228:231], v5, s[56:59], s100 offen offset:1024 sc1
    buffer_load_dwordx4 v[232:235], v5, s[56:59], s100 offen offset:2048 sc1
    buffer_load_dwordx4 v[192:195], v5, s[56:59], s100 offen offset:3072 sc1
    buffer_load_dwordx4 v[196:199], v5, s[56:59], s23 offen offset:0 sc1
    buffer_load_dwordx4 v[200:203], v5, s[56:59], s23 offen offset:1024 sc1
    buffer_load_dwordx4 v[204:207], v25, s[56:59], s23 offen offset:2048 sc1
E_51:
    s_cmp_lg_u32 s92, 0
    s_waitcnt vmcnt(9)
    v_pk_add_f32 v[20:21], v[208:209], v[212:213]
    v_pk_add_f32 v[22:23], v[210:211], v[214:215]
    v_or3_b32 v24, v208, v209, v210
    v_or3_b32 v24, v24, v211, v212
    v_or3_b32 v24, v24, v213, v214
    v_or_b32 v24, v24, v215
    s_waitcnt vmcnt(8)
    v_pk_add_f32 v[20:21], v[20:21], v[216:217]
    v_pk_add_f32 v[22:23], v[22:23], v[218:219]
    v_or3_b32 v24, v24, v216, v217
    v_or3_b32 v24, v24, v218, v219
    s_waitcnt vmcnt(7)
    v_pk_add_f32 v[20:21], v[20:21], v[220:221]
    v_pk_add_f32 v[22:23], v[22:23], v[222:223]
    v_or3_b32 v24, v24, v220, v221
    v_or3_b32 v24, v24, v222, v223
    s_waitcnt vmcnt(6)
    v_pk_add_f32 v[20:21], v[20:21], v[224:225]
    v_pk_add_f32 v[22:23], v[22:23], v[226:227]
    v_or3_b32 v24, v24, v224, v225
    v_or3_b32 v24, v24, v226, v227
    s_waitcnt vmcnt(5)
    v_pk_add_f32 v[20:21], v[20:21], v[228:229]
    v_pk_add_f32 v[22:23], v[22:23], v[230:231]
    v_or3_b32 v24, v24, v228, v229
    v_or3_b32 v24, v24, v230, v231
    s_waitcnt vmcnt(4)
    v_pk_add_f32 v[20:21], v[20:21], v[232:233]
    v_pk_add_f32 v[22:23], v[22:23], v[234:235]
    v_or3_b32 v24, v24, v232, v233
    v_or3_b32 v24, v24, v234, v235
    s_waitcnt vmcnt(3)
    v_pk_add_f32 v[20:21], v[20:21], v[192:193]
    v_pk_add_f32 v[22:23], v[22:23], v[194:195]
    v_or3_b32 v24, v24, v192, v193
    v_or3_b32 v24, v24, v194, v195
    s_waitcnt vmcnt(2)
    v_pk_add_f32 v[20:21], v[20:21], v[196:197]
    v_pk_add_f32 v[22:23], v[22:23], v[198:199]
    v_or3_b32 v24, v24, v196, v197
    v_or3_b32 v24, v24, v198, v199
    s_waitcnt vmcnt(1)
    v_pk_add_f32 v[20:21], v[20:21], v[200:201]
    v_pk_add_f32 v[22:23], v[22:23], v[202:203]
    v_or3_b32 v24, v24, v200, v201
    v_or3_b32 v24, v24, v202, v203
    s_waitcnt vmcnt(0)
    v_pk_add_f32 v[20:21], v[20:21], v[204:205]
    v_pk_add_f32 v[22:23], v[22:23], v[206:207]
    v_or3_b32 v24, v24, v204, v205
    v_or3_b32 v24, v24, v206, v207
    v_permlane32_swap_b32 v20, v22
    v_permlane32_swap_b32 v21, v23
    v_pk_add_f32 v[20:21], v[20:21], v[22:23]
    v_and_b32 v24, s97, v24
    v_cmp_ne_u32 vcc, 0, v24
    v_permlane16_swap_b32 v20, v21
    v_add_f32 v16, v20, v21
    v_cvt_pk_bf16_f32 v16, v16, v16
    v_lshlrev_b32 v16, 16, v16
    v_add_f32 v16, v16, v19
    v_cvt_pk_bf16_f32 v16, v16, v16
    v_lshlrev_b32 v16, 16, v16
    v_add_f32 v16, v16, v26
    v_cvt_pk_bf16_f32 v16, v16, v16
    ds_write_b16 v255, v16
    s_cbranch_vccnz ER_52
    buffer_store_short v16, v18, s[72:75], s91 offen
    s_cbranch_scc1 L_OUT
    v_lshlrev_b32 v1, 16, v16
    v_mov_b32 v25, v1
    v_mul_f32 v24, v1, v1
    s_mov_b32 s92, 1
    s_waitcnt lgkmcnt(0)
    s_barrier
    ds_read_b128 v[20:23], v9
    s_lshl_b32 s97, s97, 1
    v_permlane16_swap_b32 v25, v24
    v_add_f32 v25, v25, v24
    s_nop 1
    v_add_f32_dpp v25, v25, v25 quad_perm:[1,0,3,2] row_mask:0xf bank_mask:0xf
    s_nop 1
    v_add_f32_dpp v25, v25, v25 quad_perm:[2,3,0,1] row_mask:0xf bank_mask:0xf
    s_nop 1
    v_add_f32_dpp v25, v25, v25 row_half_mirror row_mask:0xf bank_mask:0xf
    s_waitcnt lgkmcnt(0)
    v_smfmac_f32_16x16x64_bf16 v[236:239], v[20:23], v[240:247], v4
    s_mov_b32 s98, 0
    v_add_f32_dpp v25, v25, v25 row_mirror row_mask:0xf bank_mask:0xf
    v_mov_b32 v18, v25
    s_nop 1
    v_permlane32_swap_b32 v25, v18
    v_add_f32 v25, v25, v18
    s_nop 0
    v_add_f32 v17, v236, v238
    v_cndmask_b32_e64 v17, v25, v17, s[4:5]
    v_and_b32 v17, -4, v17
    buffer_store_dword v17, v6, s[76:79], 0 offen
    buffer_store_dword v17, v6, s[32:35], 0 offen sc1
    s_branch L_S1D
L_S1W:
    v_and_b32 v16, 0x70, v9
    v_and_b32 v24, 0x7f, v255
    s_mov_b32 s92, 1
    s_lshl_b32 s97, s97, 1
    s_mov_b32 s98, 0
    s_waitcnt vmcnt(0) lgkmcnt(0)
    s_barrier
    ds_read_b128 v[20:23], v16 offset:18432
    s_waitcnt lgkmcnt(0)
    v_smfmac_f32_16x16x64_bf16 v[236:239], v[20:23], v[240:247], v4
    ds_read_u16 v1, v24 offset:18432
    s_nop 6
    v_add_f32 v17, v236, v238
    v_and_b32 v17, -4, v17
    buffer_store_dword v17, v6, s[76:79], 0 offen
    buffer_store_dword v17, v6, s[32:35], 0 offen sc1
    s_waitcnt lgkmcnt(0)
    v_lshlrev_b32 v1, 16, v1
L_S1D:
    s_mov_b32 s3, 1048576
    v_mov_b32 v236, 0
    v_mov_b32 v238, 0
    s_cmp_eq_u32 s85, 0
    s_cbranch_scc1 L_HOPA
    s_lshl_b32 s93, s84, 8
    s_add_u32 s93, s93, 398336
    s_cmp_lt_u32 s82, 8
    s_cselect_b32 s93, s93, 268435456
    s_cmp_eq_u32 s85, 1
    s_cselect_b32 s93, s93, 268435456
    s_waitcnt vmcnt(0)
    buffer_store_dword v1, v10, s[56:59], s93 offen sc1
    s_cmp_lt_u32 s85, 4
    s_cbranch_scc0 L_S2B
    s_setprio 1
    s_branch L_S2B
L_HOPA:
    s_setprio 1
    buffer_load_dwordx2 v[16:17], v8, s[56:59], 0 offen sc1
    buffer_load_dwordx4 v[208:211], v5, s[56:59], s43 offen offset:0 sc1
    buffer_load_dwordx4 v[212:215], v5, s[56:59], s43 offen offset:1024 sc1
    buffer_load_dwordx4 v[216:219], v5, s[56:59], s43 offen offset:2048 sc1
    buffer_load_dwordx4 v[220:223], v5, s[56:59], s43 offen offset:3072 sc1
    v_mov_b32 v224, 0
    v_mov_b32 v225, 0
    v_mov_b32 v226, 0
    v_mov_b32 v227, 0
    v_mov_b32 v228, 0
    v_mov_b32 v229, 0
    v_mov_b32 v230, 0
    v_mov_b32 v231, 0
    v_mov_b32 v232, 0
    v_mov_b32 v234, 0
    v_mov_b32 v236, 0
    v_mov_b32 v238, 0
    v_mov_b32 v192, 0
    v_mov_b32 v193, 0
    v_mov_b32 v194, 0
    v_mov_b32 v195, 0
    v_mov_b32 v196, 0
    v_mov_b32 v197, 0
    v_mov_b32 v198, 0
    v_mov_b32 v199, 0
    v_mov_b32 v200, 0
    v_mov_b32 v201, 0
    v_mov_b32 v202, 0
    v_mov_b32 v203, 0
    v_mov_b32 v204, 0
    v_mov_b32 v205, 0
    v_mov_b32 v206, 0
    v_mov_b32 v207, 0
    s_nop 0
    s_branch HA_53
HR_54:
    s_add_u32 s90, s90, 1
    s_cmp_lt_u32 s90, 400000
    s_cselect_b32 s97, s97, 0
    buffer_load_dwordx2 v[16:17], v8, s[56:59], 0 offen sc1
    buffer_load_dwordx4 v[208:211], v5, s[56:59], s43 offen offset:0 sc1
    buffer_load_dwordx4 v[212:215], v5, s[56:59], s43 offen offset:1024 sc1
    buffer_load_dwordx4 v[216:219], v5, s[56:59], s43 offen offset:2048 sc1
    buffer_load_dwordx4 v[220:223], v5, s[56:59], s43 offen offset:3072 sc1
HA_53:
    s_waitcnt vmcnt(4)
    v_add_f32_dpp v18, v16, v16 quad_perm:[1,0,3,2] row_mask:0xf bank_mask:0xf
    v_add_f32_dpp v19, v17, v17 quad_perm:[1,0,3,2] row_mask:0xf bank_mask:0xf
    v_or_b32 v26, v16, v17
    v_add_f32_dpp v18, v18, v18 quad_perm:[2,3,0,1] row_mask:0xf bank_mask:0xf
    v_add_f32_dpp v19, v19, v19 quad_perm:[2,3,0,1] row_mask:0xf bank_mask:0xf
    s_nop 0
    v_add_f32_dpp v18, v18, v18 row_half_mirror row_mask:0xf bank_mask:0xf
    v_add_f32_dpp v19, v19, v19 row_half_mirror row_mask:0xf bank_mask:0xf
    v_mul_f32 v18, 0x3b000000, v18
    v_mul_f32 v19, 0x3b000000, v19
    v_fma_f32 v18, -v19, v19, v18
    v_max_f32 v18, 0, v18
    v_add_f32 v18, 0x3727c5ac, v18
    v_rsq_f32 v18, v18
    s_waitcnt vmcnt(2)
    v_pk_add_f32 v[20:21], v[208:209], v[212:213]
    v_pk_add_f32 v[22:23], v[210:211], v[214:215]
    v_or3_b32 v26, v26, v208, v209
    v_or3_b32 v26, v26, v210, v211
    s_waitcnt vmcnt(1)
    v_pk_add_f32 v[20:21], v[20:21], v[216:217]
    v_pk_add_f32 v[22:23], v[22:23], v[218:219]
    v_or3_b32 v26, v26, v212, v213
    v_or3_b32 v26, v26, v214, v215
    s_waitcnt vmcnt(0)
    v_pk_add_f32 v[20:21], v[20:21], v[220:221]
    v_pk_add_f32 v[22:23], v[22:23], v[222:223]
    v_or3_b32 v26, v26, v216, v217
    v_or3_b32 v26, v26, v218, v219
    v_permlane32_swap_b32 v20, v22
    v_permlane32_swap_b32 v21, v23
    v_pk_add_f32 v[20:21], v[20:21], v[22:23]
    v_pk_fma_f32 v[20:21], v[248:249], v[18:19], v[20:21] op_sel:[0,1,0] op_sel_hi:[1,1,1] neg_lo:[1,0,0] neg_hi:[1,0,0]
    v_pk_mul_f32 v[20:21], v[20:21], v[18:19] op_sel:[0,0] op_sel_hi:[1,0]
    v_cvt_pk_bf16_f32 v20, v20, v21
    ds_write_b32 v7, v20 offset:0
    v_or3_b32 v26, v26, v220, v221
    v_or3_b32 v26, v26, v222, v223
    v_and_b32 v26, s97, v26
    v_cmp_ne_u32 vcc, 0, v26
    s_cbranch_vccnz HR_54
    s_waitcnt lgkmcnt(0)
L_S2B:
    s_barrier
    ds_read_b128 v[208:211], v12 offset:0
    ds_read_b128 v[212:215], v13 offset:0
    ds_read_b128 v[216:219], v14 offset:0
    ds_read_b128 v[220:223], v15 offset:0
    s_waitcnt lgkmcnt(3)
    v_smfmac_f32_16x16x64_bf16 v[224:227], v[208:211], v[32:39], v4
    v_smfmac_f32_16x16x64_bf16 v[228:231], v[208:211], v[64:71], v4
    s_waitcnt lgkmcnt(2)
    v_smfmac_f32_16x16x64_bf16 v[224:227], v[212:215], v[40:47], v4
    v_smfmac_f32_16x16x64_bf16 v[228:231], v[212:215], v[72:79], v4
    s_waitcnt lgkmcnt(1)
    v_smfmac_f32_16x16x64_bf16 v[224:227], v[216:219], v[48:55], v4
    v_smfmac_f32_16x16x64_bf16 v[228:231], v[216:219], v[80:87], v4
    s_waitcnt lgkmcnt(0)
    v_smfmac_f32_16x16x64_bf16 v[224:227], v[220:223], v[56:63], v4
    v_smfmac_f32_16x16x64_bf16 v[228:231], v[220:223], v[88:95], v4
    s_nop 6
    v_pk_add_f32 v[24:25], v[224:225], v[226:227]
    v_pk_add_f32 v[22:23], v[228:229], v[230:231]
    v_cndmask_b32_e64 v25, v22, v25, s[20:21]
    v_cndmask_b32_e64 v24, v24, v23, s[20:21]
    s_nop 1
    v_add_f32_dpp v25, v25, v24 row_ror:8 row_mask:0xf bank_mask:0xf
    v_mul_f32 v24, s30, v25
    s_nop 0
    v_max_f32_dpp v25, v25, v25 quad_perm:[1,0,3,2] row_mask:0xf bank_mask:0xf
    s_nop 1
    v_max_f32_dpp v25, v25, v25 quad_perm:[2,3,0,1] row_mask:0xf bank_mask:0xf
    s_nop 1
    v_max_f32_dpp v25, v25, v25 row_half_mirror row_mask:0xf bank_mask:0xf
    s_nop 1
    v_max_f32_dpp v25, v25, v25 row_mirror row_mask:0xf bank_mask:0xf
    v_mov_b32 v26, v25
    s_nop 1
    v_permlane16_swap_b32 v25, v26
    v_max_f32 v25, v25, v26
    v_mov_b32 v26, v25
    s_nop 1
    v_permlane32_swap_b32 v25, v26
    v_max_f32 v25, v25, v26
    v_fma_f32 v24, -v25, s30, v24
    v_exp_f32 v24, v24
    v_mul_f32 v25, s30, v25
    s_nop 0
    v_mov_b32_dpp v26, v24 quad_perm:[1,1,3,3] row_mask:0xf bank_mask:0xf
    v_cvt_pk_bf16_f32 v26, v24, v26
    ds_write2st64_b32 v29, v24, v25 offset0:56 offset1:64
    s_nop 0
    v_mov_b32_dpp v192, v26 quad_perm:[0,1,2,3] row_mask:0xf bank_mask:0x1
    v_mov_b32_dpp v193, v26 row_shl:4 row_mask:0xf bank_mask:0x1
    v_mov_b32_dpp v194, v26 row_shl:8 row_mask:0xf bank_mask:0x1
    v_mov_b32_dpp v195, v26 row_shl:12 row_mask:0xf bank_mask:0x1
    v_mov_b32_dpp v196, v26 row_shr:4 row_mask:0xf bank_mask:0x2
    v_mov_b32_dpp v197, v26 quad_perm:[0,1,2,3] row_mask:0xf bank_mask:0x2
    v_smfmac_f32_16x16x64_bf16 v[232:235], v[192:195], v[96:103], v4
    v_mov_b32_dpp v198, v26 row_shl:4 row_mask:0xf bank_mask:0x2
    v_mov_b32_dpp v199, v26 row_shl:8 row_mask:0xf bank_mask:0x2
    v_smfmac_f32_16x16x64_bf16 v[236:239], v[192:195], v[104:111], v4
    v_mov_b32_dpp v200, v26 row_shr:8 row_mask:0xf bank_mask:0x4
    v_mov_b32_dpp v201, v26 row_shr:4 row_mask:0xf bank_mask:0x4
    v_smfmac_f32_16x16x64_bf16 v[232:235], v[196:199], v[112:119], v4
    v_mov_b32_dpp v202, v26 quad_perm:[0,1,2,3] row_mask:0xf bank_mask:0x4
    v_mov_b32_dpp v203, v26 row_shl:4 row_mask:0xf bank_mask:0x4
    v_smfmac_f32_16x16x64_bf16 v[236:239], v[196:199], v[120:127], v4
    v_mov_b32_dpp v204, v26 row_shr:12 row_mask:0xf bank_mask:0x8
    v_mov_b32_dpp v205, v26 row_shr:8 row_mask:0xf bank_mask:0x8
    v_mov_b32_dpp v206, v26 row_shr:4 row_mask:0xf bank_mask:0x8
    v_mov_b32_dpp v207, v26 quad_perm:[0,1,2,3] row_mask:0xf bank_mask:0x8
    ds_read_b32 v23, v28 offset:16384
    v_smfmac_f32_16x16x64_bf16 v[232:235], v[200:203], v[128:135], v4
    v_smfmac_f32_16x16x64_bf16 v[236:239], v[200:203], v[136:143], v4
    v_smfmac_f32_16x16x64_bf16 v[232:235], v[204:207], v[144:151], v4
    s_waitcnt lgkmcnt(0)
    v_max_f32_dpp v22, v23, v23 quad_perm:[1,0,3,2] row_mask:0xf bank_mask:0xf
    v_smfmac_f32_16x16x64_bf16 v[236:239], v[204:207], v[152:159], v4
    s_nop 0
    v_max_f32_dpp v22, v22, v22 quad_perm:[2,3,0,1] row_mask:0xf bank_mask:0xf
    s_nop 1
    v_max_f32_dpp v22, v22, v22 row_half_mirror row_mask:0xf bank_mask:0xf
    v_sub_f32 v20, v25, v22
    v_cmp_eq_f32 vcc, s25, v22
    v_exp_f32 v20, v20
    s_cbranch_vccnz L_FRETRY
FOK_55:
    v_add_f32 v18, v232, v234
    v_add_f32 v19, v236, v238
    v_pk_mul_f32 v[18:19], v[18:19], v[20:21] op_sel:[0,0] op_sel_hi:[1,0]
    ds_write_b64 v31, v[18:19] offset:1024
    s_setprio 0
    s_cmp_lg_u32 s85, 1
    s_cbranch_scc1 L_B2
    v_lshlrev_b32 v16, 1, v5
    v_and_b32 v17, 0x700, v16
    ds_read_b32 v23, v17 offset:16384
    ds_read_b128 v[208:211], v16 offset:14336
    ds_read_b128 v[212:215], v16 offset:14352
    s_waitcnt lgkmcnt(2)
    v_sub_f32 v23, v23, v22
    v_exp_f32 v23, v23
    s_waitcnt lgkmcnt(0)
    v_pk_add_f32 v[208:209], v[208:209], v[210:211]
    v_pk_add_f32 v[212:213], v[212:213], v[214:215]
    v_pk_add_f32 v[208:209], v[208:209], v[212:213]
    v_add_f32 v16, v208, v209
    v_mul_f32 v23, v23, v16
    s_nop 0
    s_branch L_B2
L_FRETRY:
    s_mov_b32 s101, 0
MW_56:
    ds_read_b32 v23, v28 offset:16384
    s_add_u32 s101, s101, 1
    s_cmp_lt_u32 s101, 100000
    s_cselect_b32 s99, s25, 0x7fc00000
    s_waitcnt lgkmcnt(0)
    v_max_f32_dpp v22, v23, v23 quad_perm:[1,0,3,2] row_mask:0xf bank_mask:0xf
    s_nop 1
    v_max_f32_dpp v22, v22, v22 quad_perm:[2,3,0,1] row_mask:0xf bank_mask:0xf
    s_nop 1
    v_max_f32_dpp v22, v22, v22 row_half_mirror row_mask:0xf bank_mask:0xf
    v_cmp_eq_f32 vcc, s99, v22
    s_cbranch_vccnz MW_56
    v_sub_f32 v20, v25, v22
    v_exp_f32 v20, v20
    s_nop 0
    s_branch FOK_55
L_OUT:
    s_endpgm
    s_or_b32 s93, s82, s85
    s_cbranch_scc1 NOEP_57
NOEP_57:
L_FIN:
L_END:
    s_endpgm
.section .rodata,"a"
.p2align 6
.amdhsa_kernel interleave_layers__mha_block_cached__dense_activation_gelu__decode_kernel
  .amdhsa_next_free_vgpr 256
  .amdhsa_next_free_sgpr 102
  .amdhsa_accum_offset 256
  .amdhsa_group_segment_fixed_size 0
  .amdhsa_kernarg_size 104
  .amdhsa_user_sgpr_count 2
  .amdhsa_user_sgpr_kernarg_segment_ptr 1
  .amdhsa_system_sgpr_workgroup_id_x 1
.end_amdhsa_kernel
```
